```python
import torch

def _softmax(x, axis=-1):
    return torch.softmax(x, dim=axis)
def _gelu(x):
    return torch.nn.functional.gelu(x, approximate="tanh")
def _silu(x):
    return torch.nn.functional.silu(x)
def _sigmoid(x):
    return torch.sigmoid(x)
def _layernorm(x, axis=-1, eps=1e-5):
    m = x.mean(dim=axis, keepdim=True)
    v = x.var(dim=axis, keepdim=True, unbiased=False)
    return (x - m) / torch.sqrt(v + eps)
def _scatter_add(tgt, idx, src, axis=0):
    return tgt.clone().index_add_(axis, idx, src)
def _segment_sum(src, seg, n):
    out = torch.zeros((n,) + src.shape[1:], dtype=src.dtype)
    return out.index_add_(0, seg, src)
def _pad(x, pw):
    flat = tuple(v for pair in reversed(pw) for v in pair)
    return torch.nn.functional.pad(x, flat)

kernel_name = 'sequential_preLN__sliding_local_dilated__dense_activation_gelu__prompt'

def setup_inputs():

    _w = (lambda a: (lambda t: t.to(torch.bfloat16) if t.is_floating_point() else t)(torch.as_tensor(a)))
    def _A_setup():
        B, S, D = 1, 2048, 1024
        return {
            "x": _w((lambda *s: torch.randn(*s, dtype=torch.bfloat16) * 0.05)(B, S, D)),
            "wqkv": _w((lambda *s: torch.randn(*s, dtype=torch.bfloat16) * 0.05)(D, 3 * D)),
            "wo": _w((lambda *s: torch.randn(*s, dtype=torch.bfloat16) * 0.05)(D, D)),
        }
    _A_in = _A_setup()

    def _B_setup():
        B, S, D, F = 1, 2048, 1024, 3584
        return {
            "x": _w((lambda *s: torch.randn(*s, dtype=torch.bfloat16) * 0.05)(B, S, D)),
            "w1": _w((lambda *s: torch.randn(*s, dtype=torch.bfloat16) * 3.2)(D, F) * (D ** -0.5)),
            "b1": _w((lambda *s: torch.randn(*s, dtype=torch.bfloat16) * 3.2)(F) * 0.01),
            "w2": _w((lambda *s: torch.randn(*s, dtype=torch.bfloat16) * 0.4)(F, D) * (F ** -0.5)),
            "b2": _w((lambda *s: torch.randn(*s, dtype=torch.bfloat16) * 0.4)(D) * 0.01),
        }
    _B_in = _B_setup()

    return {
        "A_x": _A_in["x"],
        "A_wqkv": _A_in["wqkv"],
        "A_wo": _A_in["wo"],
        "B_x": _B_in["x"],
        "B_w1": _B_in["w1"],
        "B_b1": _B_in["b1"],
        "B_w2": _B_in["w2"],
        "B_b2": _B_in["b2"],
    }

def reference(A_x, A_wqkv, A_wo, B_x, B_w1, B_b1, B_w2, B_b2):
    def _A_ref(x, wqkv, wo):
        B, S, D = x.shape
        H = 32; Dh = D // H
        W, dil = 8, 2
        qkv = (lambda x, *d: x.permute(*d))((x @ wqkv).reshape(B, S, 3, H, Dh), 2, 0, 3, 1, 4)
        q, k, v = qkv[0], qkv[1], qkv[2]
        scale = Dh ** -0.5
        pos = torch.arange(S)
        off = torch.arange(W) * dil
        idx = pos[:, None] - off[None, :]
        mask = idx >= 0
        idx_c = torch.where(mask, idx, 0).reshape(-1)
        kg = k[:, :, idx_c, :].reshape(B, H, S, W, Dh)
        vg = v[:, :, idx_c, :].reshape(B, H, S, W, Dh)
        logits = torch.einsum("bhsd,bhswd->bhsw", q, kg) * scale
        logits = torch.where(mask[None, None, :, :], logits, -1e9)
        attn = _softmax(logits, axis=-1)
        o = torch.einsum("bhsw,bhswd->bhsd", attn, vg)
        return (lambda x, *d: x.permute(*d))(o, 0, 2, 1, 3).reshape(B, S, D) @ wo

    def _B_ref(x, w1, b1, w2, b2):
        h = torch.einsum("bsd,df->bsf", x, w1) + b1
        h = _gelu(h)
        return torch.einsum("bsf,fd->bsd", h, w2) + b2

    x = A_x
    h = x + _A_ref(_layernorm(x, axis=-1), A_wqkv, A_wo)
    h2 = h + _B_ref(_layernorm(h, axis=-1), B_w1, B_b1, B_w2, B_b2)
    return h2
```

```asm
; @launch grid=(256,1,1) block=(512,1,1) lds=163840
.amdgcn_target "amdgcn-amd-amdhsa--gfx950"
.text
.globl sequential_preLN__sliding_local_dilated__dense_activation_gelu__prompt_kernel
.p2align 8
.type sequential_preLN__sliding_local_dilated__dense_activation_gelu__prompt_kernel,@function
sequential_preLN__sliding_local_dilated__dense_activation_gelu__prompt_kernel:
KSTART:
    s_cmp_ge_u32 s2, 256
    s_cbranch_scc1 L_done
    s_load_dwordx16 s[4:19], s[0:1], 0
    s_load_dwordx4 s[20:23], s[0:1], 64
    s_load_dwordx2 s[24:25], s[0:1], 80
    v_lshrrev_b32 v1, 6, v0
    v_and_b32 v0, 63, v0
    s_nop 0
    v_readfirstlane_b32 s26, v1
    s_and_b32 s27, s26, 3
    s_and_b32 s53, s2, 1
    s_lshl_b32 s53, s53, 3
    s_lshr_b32 s54, s2, 3
    s_and_b32 s55, s54, 7
    s_add_u32 s44, s53, s55
    s_and_b32 s53, s2, 7
    s_lshr_b32 s53, s53, 1
    s_lshl_b32 s53, s53, 2
    s_lshr_b32 s54, s2, 6
    s_add_u32 s45, s53, s54
    s_add_u32 s47, s44, s45
    s_and_b32 s47, s47, 3
    s_cmp_ge_u32 s26, 4
    s_cbranch_scc1 L_prod
    s_lshl_b32 s61, s44, 4
    s_add_u32 s61, s61, s45
    s_waitcnt lgkmcnt(0)
    s_add_u32 s96, s24, 50331648
    s_addc_u32 s97, s25, 0
    s_mov_b32 s98, 1048576
    s_mov_b32 s99, 0x20000
    s_mov_b32 s28, s4
    s_mov_b32 s29, s5
    s_mov_b32 s30, 4194304
    s_mov_b32 s31, 0x20000
    v_lshlrev_b32 v1, 4, v0
    s_lshl_b32 s53, s61, 14
    s_lshl_b32 s54, s27, 12
    s_add_u32 s53, s53, s54
    buffer_load_dwordx4 v[16:19], v1, s[28:31], s53 offen offset:0
    buffer_load_dwordx4 v[20:23], v1, s[28:31], s53 offen offset:1024
    buffer_load_dwordx4 v[24:27], v1, s[28:31], s53 offen offset:2048
    buffer_load_dwordx4 v[28:31], v1, s[28:31], s53 offen offset:3072
    s_load_dword s62, s[96:97], 0
    s_lshr_b32 s53, s27, 1
    s_and_b32 s54, s27, 1
    s_lshl_b32 s55, s53, 13
    v_and_b32 v10, 15, v0
    v_lshrrev_b32 v11, 1, v10
    v_lshrrev_b32 v2, 4, v0
    v_xor_b32 v2, v2, v11
    v_lshlrev_b32 v2, 4, v2
    v_lshlrev_b32 v10, 7, v10
    v_add_u32 v2, v2, v10
    v_add_u32 v2, s55, v2
    v_xor_b32 v3, 64, v2
    v_lshrrev_b32 v10, 4, v0
    v_lshlrev_b32 v10, 10, v10
    v_bfe_u32 v11, v0, 2, 2
    v_lshlrev_b32 v11, 7, v11
    v_add_u32 v10, v10, v11
    v_and_b32 v11, 3, v0
    v_lshlrev_b32 v11, 3, v11
    v_add_u32 v10, v10, v11
    v_add_u32 v10, 18432, v10
    v_bfe_u32 v11, v0, 3, 2
    s_lshl_b32 s55, s54, 1
    s_add_u32 s55, s55, 0
    v_xor_b32 v4, s55, v11
    v_lshlrev_b32 v4, 5, v4
    v_add_u32 v4, v4, v10
    s_lshl_b32 s55, s54, 1
    s_add_u32 s55, s55, 1
    v_xor_b32 v5, s55, v11
    v_lshlrev_b32 v5, 5, v5
    v_add_u32 v5, v5, v10
    v_and_b32 v10, 15, v0
    v_lshrrev_b32 v11, 4, v0
    v_lshlrev_b32 v11, 2, v11
    v_sub_u32 v10, v10, v11
    v_mov_b32 v12, 0xf149f2ca
    v_add_u32 v11, 16, v10
    v_and_b32 v11, 0xfffffff1, v11
    v_cmp_eq_u32 vcc, 0, v11
    s_nop 1
    v_cndmask_b32 v224, v12, 0, vcc
    v_add_u32 v11, 15, v10
    v_and_b32 v11, 0xfffffff1, v11
    v_cmp_eq_u32 vcc, 0, v11
    s_nop 1
    v_cndmask_b32 v225, v12, 0, vcc
    v_add_u32 v11, 14, v10
    v_and_b32 v11, 0xfffffff1, v11
    v_cmp_eq_u32 vcc, 0, v11
    s_nop 1
    v_cndmask_b32 v226, v12, 0, vcc
    v_add_u32 v11, 13, v10
    v_and_b32 v11, 0xfffffff1, v11
    v_cmp_eq_u32 vcc, 0, v11
    s_nop 1
    v_cndmask_b32 v227, v12, 0, vcc
    v_add_u32 v11, 0, v10
    v_and_b32 v11, 0xfffffff1, v11
    v_cmp_eq_u32 vcc, 0, v11
    s_nop 1
    v_cndmask_b32 v228, v12, 0, vcc
    v_add_u32 v11, -1, v10
    v_and_b32 v11, 0xfffffff1, v11
    v_cmp_eq_u32 vcc, 0, v11
    s_nop 1
    v_cndmask_b32 v229, v12, 0, vcc
    v_add_u32 v11, -2, v10
    v_and_b32 v11, 0xfffffff1, v11
    v_cmp_eq_u32 vcc, 0, v11
    s_nop 1
    v_cndmask_b32 v230, v12, 0, vcc
    v_add_u32 v11, -3, v10
    v_and_b32 v11, 0xfffffff1, v11
    v_cmp_eq_u32 vcc, 0, v11
    s_nop 1
    v_cndmask_b32 v231, v12, 0, vcc
    s_lshl_b32 s55, s44, 1
    s_add_u32 s55, s55, s53
    s_cmp_eq_u32 s55, 0
    s_cselect_b64 vcc, -1, 0
    v_cndmask_b32 v232, v224, v12, vcc
    v_cndmask_b32 v233, v225, v12, vcc
    v_cndmask_b32 v234, v226, v12, vcc
    v_cndmask_b32 v235, v227, v12, vcc
    s_waitcnt lgkmcnt(0)
    s_add_u32 s62, s62, 1
    s_add_u32 s36, s24, 31457280
    s_addc_u32 s37, s25, 0
    s_mov_b32 s38, 16384
    s_mov_b32 s39, 0x20000
    s_lshl_b32 s53, s61, 6
    s_lshl_b32 s54, s27, 4
    s_add_u32 s53, s53, s54
    v_mov_b32 v1, 0
    s_waitcnt vmcnt(0)
    v_lshlrev_b32 v32, 16, v16
    v_and_b32 v33, 0xffff0000, v16
    v_lshlrev_b32 v34, 16, v17
    v_and_b32 v35, 0xffff0000, v17
    v_lshlrev_b32 v36, 16, v18
    v_and_b32 v37, 0xffff0000, v18
    v_lshlrev_b32 v38, 16, v19
    v_and_b32 v39, 0xffff0000, v19
    v_lshlrev_b32 v40, 16, v20
    v_and_b32 v41, 0xffff0000, v20
    v_lshlrev_b32 v42, 16, v21
    v_and_b32 v43, 0xffff0000, v21
    v_lshlrev_b32 v44, 16, v22
    v_and_b32 v45, 0xffff0000, v22
    v_lshlrev_b32 v46, 16, v23
    v_and_b32 v47, 0xffff0000, v23
    v_lshlrev_b32 v48, 16, v24
    v_and_b32 v49, 0xffff0000, v24
    v_lshlrev_b32 v50, 16, v25
    v_and_b32 v51, 0xffff0000, v25
    v_lshlrev_b32 v52, 16, v26
    v_and_b32 v53, 0xffff0000, v26
    v_lshlrev_b32 v54, 16, v27
    v_and_b32 v55, 0xffff0000, v27
    v_lshlrev_b32 v56, 16, v28
    v_and_b32 v57, 0xffff0000, v28
    v_lshlrev_b32 v58, 16, v29
    v_and_b32 v59, 0xffff0000, v29
    v_lshlrev_b32 v60, 16, v30
    v_and_b32 v61, 0xffff0000, v30
    v_lshlrev_b32 v62, 16, v31
    v_and_b32 v63, 0xffff0000, v31
    v_pk_add_f32 v[64:65], v[32:33], v[34:35]
    v_pk_add_f32 v[72:73], v[48:49], v[50:51]
    v_pk_add_f32 v[66:67], v[36:37], v[38:39]
    v_pk_add_f32 v[74:75], v[52:53], v[54:55]
    v_pk_add_f32 v[68:69], v[40:41], v[42:43]
    v_pk_add_f32 v[76:77], v[56:57], v[58:59]
    v_pk_add_f32 v[70:71], v[44:45], v[46:47]
    v_pk_add_f32 v[78:79], v[60:61], v[62:63]
    v_pk_add_f32 v[64:65], v[64:65], v[66:67]
    v_pk_add_f32 v[72:73], v[72:73], v[74:75]
    v_pk_add_f32 v[68:69], v[68:69], v[70:71]
    v_pk_add_f32 v[76:77], v[76:77], v[78:79]
    v_pk_add_f32 v[64:65], v[64:65], v[68:69]
    v_pk_add_f32 v[72:73], v[72:73], v[76:77]
    v_add_f32 v64, v64, v65
    v_add_f32 v72, v72, v73
    s_nop 0
    v_add_f32_dpp v64, v64, v64 quad_perm:[1,0,3,2] row_mask:0xf bank_mask:0xf
    v_add_f32_dpp v72, v72, v72 quad_perm:[1,0,3,2] row_mask:0xf bank_mask:0xf
    s_nop 0
    v_add_f32_dpp v64, v64, v64 quad_perm:[2,3,0,1] row_mask:0xf bank_mask:0xf
    v_add_f32_dpp v72, v72, v72 quad_perm:[2,3,0,1] row_mask:0xf bank_mask:0xf
    s_nop 0
    v_add_f32_dpp v64, v64, v64 row_half_mirror row_mask:0xf bank_mask:0xf
    v_add_f32_dpp v72, v72, v72 row_half_mirror row_mask:0xf bank_mask:0xf
    s_nop 0
    v_add_f32_dpp v64, v64, v64 row_mirror row_mask:0xf bank_mask:0xf
    v_add_f32_dpp v72, v72, v72 row_mirror row_mask:0xf bank_mask:0xf
    v_mov_b32 v65, v64
    v_mov_b32 v73, v72
    s_nop 0
    v_permlane16_swap_b32 v65, v64
    v_permlane16_swap_b32 v73, v72
    v_add_f32 v64, v65, v64
    v_add_f32 v72, v73, v72
    v_mov_b32 v65, v64
    v_mov_b32 v73, v72
    s_nop 0
    v_permlane32_swap_b32 v65, v64
    v_permlane32_swap_b32 v73, v72
    v_add_f32 v64, v65, v64
    v_add_f32 v72, v73, v72
    v_mul_f32 v64, 0x3a800000, v64
    v_mul_f32 v72, 0x3a800000, v72
    v_pk_add_f32 v[32:33], v[32:33], v[64:65] op_sel_hi:[1,0] neg_lo:[0,1] neg_hi:[0,1]
    v_pk_add_f32 v[48:49], v[48:49], v[72:73] op_sel_hi:[1,0] neg_lo:[0,1] neg_hi:[0,1]
    v_pk_add_f32 v[34:35], v[34:35], v[64:65] op_sel_hi:[1,0] neg_lo:[0,1] neg_hi:[0,1]
    v_pk_add_f32 v[50:51], v[50:51], v[72:73] op_sel_hi:[1,0] neg_lo:[0,1] neg_hi:[0,1]
    v_pk_add_f32 v[36:37], v[36:37], v[64:65] op_sel_hi:[1,0] neg_lo:[0,1] neg_hi:[0,1]
    v_pk_add_f32 v[52:53], v[52:53], v[72:73] op_sel_hi:[1,0] neg_lo:[0,1] neg_hi:[0,1]
    v_pk_add_f32 v[38:39], v[38:39], v[64:65] op_sel_hi:[1,0] neg_lo:[0,1] neg_hi:[0,1]
    v_pk_add_f32 v[54:55], v[54:55], v[72:73] op_sel_hi:[1,0] neg_lo:[0,1] neg_hi:[0,1]
    v_pk_add_f32 v[40:41], v[40:41], v[64:65] op_sel_hi:[1,0] neg_lo:[0,1] neg_hi:[0,1]
    v_pk_add_f32 v[56:57], v[56:57], v[72:73] op_sel_hi:[1,0] neg_lo:[0,1] neg_hi:[0,1]
    v_pk_add_f32 v[42:43], v[42:43], v[64:65] op_sel_hi:[1,0] neg_lo:[0,1] neg_hi:[0,1]
    v_pk_add_f32 v[58:59], v[58:59], v[72:73] op_sel_hi:[1,0] neg_lo:[0,1] neg_hi:[0,1]
    v_pk_add_f32 v[44:45], v[44:45], v[64:65] op_sel_hi:[1,0] neg_lo:[0,1] neg_hi:[0,1]
    v_pk_add_f32 v[60:61], v[60:61], v[72:73] op_sel_hi:[1,0] neg_lo:[0,1] neg_hi:[0,1]
    v_pk_add_f32 v[46:47], v[46:47], v[64:65] op_sel_hi:[1,0] neg_lo:[0,1] neg_hi:[0,1]
    v_pk_add_f32 v[62:63], v[62:63], v[72:73] op_sel_hi:[1,0] neg_lo:[0,1] neg_hi:[0,1]
    v_pk_mul_f32 v[32:33], v[32:33], v[32:33]
    v_pk_mul_f32 v[34:35], v[34:35], v[34:35]
    v_pk_mul_f32 v[36:37], v[36:37], v[36:37]
    v_pk_mul_f32 v[38:39], v[38:39], v[38:39]
    v_pk_mul_f32 v[40:41], v[40:41], v[40:41]
    v_pk_mul_f32 v[42:43], v[42:43], v[42:43]
    v_pk_mul_f32 v[44:45], v[44:45], v[44:45]
    v_pk_mul_f32 v[46:47], v[46:47], v[46:47]
    v_pk_mul_f32 v[48:49], v[48:49], v[48:49]
    v_pk_mul_f32 v[50:51], v[50:51], v[50:51]
    v_pk_mul_f32 v[52:53], v[52:53], v[52:53]
    v_pk_mul_f32 v[54:55], v[54:55], v[54:55]
    v_pk_mul_f32 v[56:57], v[56:57], v[56:57]
    v_pk_mul_f32 v[58:59], v[58:59], v[58:59]
    v_pk_mul_f32 v[60:61], v[60:61], v[60:61]
    v_pk_mul_f32 v[62:63], v[62:63], v[62:63]
    v_pk_add_f32 v[80:81], v[32:33], v[34:35]
    v_pk_add_f32 v[88:89], v[48:49], v[50:51]
    v_pk_add_f32 v[82:83], v[36:37], v[38:39]
    v_pk_add_f32 v[90:91], v[52:53], v[54:55]
    v_pk_add_f32 v[84:85], v[40:41], v[42:43]
    v_pk_add_f32 v[92:93], v[56:57], v[58:59]
    v_pk_add_f32 v[86:87], v[44:45], v[46:47]
    v_pk_add_f32 v[94:95], v[60:61], v[62:63]
    v_pk_add_f32 v[80:81], v[80:81], v[82:83]
    v_pk_add_f32 v[88:89], v[88:89], v[90:91]
    v_pk_add_f32 v[84:85], v[84:85], v[86:87]
    v_pk_add_f32 v[92:93], v[92:93], v[94:95]
    v_pk_add_f32 v[80:81], v[80:81], v[84:85]
    v_pk_add_f32 v[88:89], v[88:89], v[92:93]
    v_add_f32 v80, v80, v81
    v_add_f32 v88, v88, v89
    s_nop 0
    v_add_f32_dpp v80, v80, v80 quad_perm:[1,0,3,2] row_mask:0xf bank_mask:0xf
    v_add_f32_dpp v88, v88, v88 quad_perm:[1,0,3,2] row_mask:0xf bank_mask:0xf
    s_nop 0
    v_add_f32_dpp v80, v80, v80 quad_perm:[2,3,0,1] row_mask:0xf bank_mask:0xf
    v_add_f32_dpp v88, v88, v88 quad_perm:[2,3,0,1] row_mask:0xf bank_mask:0xf
    s_nop 0
    v_add_f32_dpp v80, v80, v80 row_half_mirror row_mask:0xf bank_mask:0xf
    v_add_f32_dpp v88, v88, v88 row_half_mirror row_mask:0xf bank_mask:0xf
    s_nop 0
    v_add_f32_dpp v80, v80, v80 row_mirror row_mask:0xf bank_mask:0xf
    v_add_f32_dpp v88, v88, v88 row_mirror row_mask:0xf bank_mask:0xf
    v_mov_b32 v81, v80
    v_mov_b32 v89, v88
    s_nop 0
    v_permlane16_swap_b32 v81, v80
    v_permlane16_swap_b32 v89, v88
    v_add_f32 v80, v81, v80
    v_add_f32 v88, v89, v88
    v_mov_b32 v81, v80
    v_mov_b32 v89, v88
    s_nop 0
    v_permlane32_swap_b32 v81, v80
    v_permlane32_swap_b32 v89, v88
    v_add_f32 v80, v81, v80
    v_add_f32 v88, v89, v88
    v_mul_f32 v80, 0x3a800000, v80
    v_mul_f32 v88, 0x3a800000, v88
    v_cvt_pk_bf16_f32 v80, v80, v88
    v_and_b32 v81, 0xffff0000, v80
    v_lshlrev_b32 v80, 16, v80
    v_add_f32 v80, 0x3727c5ac, v80
    v_add_f32 v81, 0x3727c5ac, v81
    v_cvt_pk_bf16_f32 v80, v80, v81
    v_and_b32 v81, 0xffff0000, v80
    v_lshlrev_b32 v80, 16, v80
    v_sqrt_f32 v80, v80
    v_sqrt_f32 v81, v81
    s_nop 0
    v_cvt_pk_bf16_f32 v84, v64, v80
    v_cvt_pk_bf16_f32 v86, v72, v81
    v_mov_b32 v85, s62
    v_mov_b32 v87, s62
    s_mov_b64 exec, 1
    buffer_store_dwordx4 v[84:87], v1, s[36:39], s53 offen sc1
    s_mov_b64 exec, -1
    s_lshr_b32 s53, s27, 1
    s_and_b32 s54, s27, 1
    s_lshl_b32 s55, s53, 9
    s_add_u32 s55, s55, 154368
    v_and_b32 v6, 15, v0
    v_lshlrev_b32 v7, 3, v6
    v_add_u32 v7, s55, v7
    s_lshl_b32 s55, s53, 8
    s_add_u32 s55, s55, 155520
    v_and_b32 v8, 0x30, v0
    v_add_u32 v9, s55, v8
    s_lshl_b32 s55, s54, 7
    s_add_u32 s55, s55, 153600
    v_add_u32 v8, s55, v8
    v_lshlrev_b32 v6, 2, v6
    v_add_u32 v6, s55, v6
    s_mul_i32 s84, s54, 3072
    s_add_u32 s84, s84, 139264
    s_lshl_b32 s85, s27, 2
    s_add_u32 s85, s85, 160272
    s_xor_b32 s86, s85, 8
    s_lshl_b32 s87, s44, 1
    s_add_u32 s87, s87, s53
    s_lshl_b32 s87, s87, 17
    s_lshl_b32 s56, s45, 1
    s_add_u32 s56, s56, s54
    s_lshl_b32 s56, s56, 10
    s_add_u32 s87, s87, s56
    s_cmp_ge_u32 s27, 2
    s_cbranch_scc1 L_rh1
    s_mov_b32 s51, 0
    s_mov_b32 s52, 14
    s_mov_b32 s54, 0xfffeb000
    s_mov_b32 s55, 43008
    s_barrier
    ds_read_b128 v[16:19], v2 offset:0
    ds_read_b128 v[20:23], v2 offset:2048
    ds_read_b128 v[24:27], v2 offset:4096
    ds_read_b128 v[28:31], v2 offset:6144
    ds_read_b128 v[32:35], v2 offset:8192
    ds_read_b64_tr_b16 v[56:57], v4 offset:0
    ds_read_b64_tr_b16 v[58:59], v4 offset:512
    ds_read_b64_tr_b16 v[60:61], v5 offset:0
    ds_read_b64_tr_b16 v[62:63], v5 offset:512
    ds_read_b64_tr_b16 v[64:65], v4 offset:8192
    ds_read_b64_tr_b16 v[66:67], v4 offset:8704
    ds_read_b64_tr_b16 v[68:69], v5 offset:8192
    ds_read_b64_tr_b16 v[70:71], v5 offset:8704
    ds_read_b64_tr_b16 v[72:73], v4 offset:16384
    ds_read_b64_tr_b16 v[74:75], v4 offset:16896
    ds_read_b64_tr_b16 v[76:77], v5 offset:16384
    ds_read_b64_tr_b16 v[78:79], v5 offset:16896
    s_waitcnt lgkmcnt(0)
    v_mfma_f32_16x16x32_bf16 v[112:115], v[64:67], v[16:19], 0
    ds_read_b128 v[36:39], v3 offset:0
    v_mfma_f32_16x16x32_bf16 v[116:119], v[68:71], v[16:19], 0
    ds_read_b128 v[40:43], v3 offset:2048
    v_mfma_f32_16x16x32_bf16 v[152:155], v[16:19], v[72:75], 0
    ds_read_b128 v[44:47], v3 offset:4096
    v_mfma_f32_16x16x32_bf16 v[156:159], v[16:19], v[76:79], 0
    ds_read_b128 v[48:51], v3 offset:6144
    v_mfma_f32_16x16x32_bf16 v[196:199], v[60:63], v[20:23], 0
    ds_read_b128 v[52:55], v3 offset:8192
    v_mfma_f32_16x16x32_bf16 v[192:195], v[56:59], v[20:23], 0
    ds_read_b64_tr_b16 v[80:81], v4 offset:4096
    v_mfma_f32_16x16x32_bf16 v[164:167], v[20:23], v[76:79], 0
    ds_read_b64_tr_b16 v[82:83], v4 offset:4608
    v_mfma_f32_16x16x32_bf16 v[160:163], v[20:23], v[72:75], 0
    ds_read_b64_tr_b16 v[84:85], v5 offset:4096
    v_mfma_f32_16x16x32_bf16 v[124:127], v[68:71], v[20:23], 0
    ds_read_b64_tr_b16 v[86:87], v5 offset:4608
    v_mfma_f32_16x16x32_bf16 v[120:123], v[64:67], v[20:23], 0
    ds_read_b64_tr_b16 v[88:89], v4 offset:12288
    v_mfma_f32_16x16x32_bf16 v[128:131], v[64:67], v[24:27], 0
    ds_read_b64_tr_b16 v[90:91], v4 offset:12800
    v_mfma_f32_16x16x32_bf16 v[132:135], v[68:71], v[24:27], 0
    ds_read_b64_tr_b16 v[92:93], v5 offset:12288
    v_mfma_f32_16x16x32_bf16 v[168:171], v[24:27], v[72:75], 0
    ds_read_b64_tr_b16 v[94:95], v5 offset:12800
    v_mfma_f32_16x16x32_bf16 v[172:175], v[24:27], v[76:79], 0
    ds_read_b64_tr_b16 v[96:97], v4 offset:20480
    v_mfma_f32_16x16x32_bf16 v[200:203], v[56:59], v[24:27], 0
    ds_read_b64_tr_b16 v[98:99], v4 offset:20992
    v_mfma_f32_16x16x32_bf16 v[204:207], v[60:63], v[24:27], 0
    ds_read_b64_tr_b16 v[100:101], v5 offset:20480
    v_mfma_f32_16x16x32_bf16 v[212:215], v[60:63], v[28:31], 0
    ds_read_b64_tr_b16 v[102:103], v5 offset:20992
    v_mfma_f32_16x16x32_bf16 v[208:211], v[56:59], v[28:31], 0
    v_mfma_f32_16x16x32_bf16 v[180:183], v[28:31], v[76:79], 0
    s_add_u32 s51, s51, 43008
    s_cmp_ge_u32 s51, 129024
    v_mfma_f32_16x16x32_bf16 v[176:179], v[28:31], v[72:75], 0
    s_cselect_b32 s51, 0, s51
    v_mfma_f32_16x16x32_bf16 v[140:143], v[68:71], v[28:31], 0
    s_cselect_b32 s53, s54, s55
    v_mfma_f32_16x16x32_bf16 v[136:139], v[64:67], v[28:31], 0
    v_add_u32 v2, s53, v2
    v_mfma_f32_16x16x32_bf16 v[144:147], v[64:67], v[32:35], 0
    v_add_u32 v3, s53, v3
    v_mfma_f32_16x16x32_bf16 v[148:151], v[68:71], v[32:35], 0
    v_add_u32 v4, s53, v4
    v_mfma_f32_16x16x32_bf16 v[184:187], v[32:35], v[72:75], 0
    v_add_u32 v5, s53, v5
    v_mfma_f32_16x16x32_bf16 v[188:191], v[32:35], v[76:79], 0
cloop_1:
    s_waitcnt lgkmcnt(0)
    v_mfma_f32_16x16x32_bf16 v[112:115], v[88:91], v[36:39], v[112:115]
    v_mfma_f32_16x16x32_bf16 v[116:119], v[92:95], v[36:39], v[116:119]
    v_mfma_f32_16x16x32_bf16 v[152:155], v[36:39], v[96:99], v[152:155]
    v_mfma_f32_16x16x32_bf16 v[156:159], v[36:39], v[100:103], v[156:159]
    s_barrier
    v_mfma_f32_16x16x32_bf16 v[196:199], v[84:87], v[40:43], v[196:199]
    ds_read_b128 v[16:19], v2 offset:0
    v_mfma_f32_16x16x32_bf16 v[192:195], v[80:83], v[40:43], v[192:195]
    ds_read_b128 v[20:23], v2 offset:2048
    v_mfma_f32_16x16x32_bf16 v[164:167], v[40:43], v[100:103], v[164:167]
    ds_read_b128 v[24:27], v2 offset:4096
    v_mfma_f32_16x16x32_bf16 v[160:163], v[40:43], v[96:99], v[160:163]
    ds_read_b128 v[28:31], v2 offset:6144
    v_mfma_f32_16x16x32_bf16 v[124:127], v[92:95], v[40:43], v[124:127]
    ds_read_b128 v[32:35], v2 offset:8192
    v_mfma_f32_16x16x32_bf16 v[120:123], v[88:91], v[40:43], v[120:123]
    ds_read_b64_tr_b16 v[56:57], v4 offset:0
    v_mfma_f32_16x16x32_bf16 v[128:131], v[88:91], v[44:47], v[128:131]
    ds_read_b64_tr_b16 v[58:59], v4 offset:512
    v_mfma_f32_16x16x32_bf16 v[132:135], v[92:95], v[44:47], v[132:135]
    ds_read_b64_tr_b16 v[60:61], v5 offset:0
    v_mfma_f32_16x16x32_bf16 v[168:171], v[44:47], v[96:99], v[168:171]
    ds_read_b64_tr_b16 v[62:63], v5 offset:512
    v_mfma_f32_16x16x32_bf16 v[172:175], v[44:47], v[100:103], v[172:175]
    ds_read_b64_tr_b16 v[64:65], v4 offset:8192
    v_mfma_f32_16x16x32_bf16 v[200:203], v[80:83], v[44:47], v[200:203]
    ds_read_b64_tr_b16 v[66:67], v4 offset:8704
    v_mfma_f32_16x16x32_bf16 v[204:207], v[84:87], v[44:47], v[204:207]
    ds_read_b64_tr_b16 v[68:69], v5 offset:8192
    v_mfma_f32_16x16x32_bf16 v[212:215], v[84:87], v[48:51], v[212:215]
    ds_read_b64_tr_b16 v[70:71], v5 offset:8704
    v_mfma_f32_16x16x32_bf16 v[208:211], v[80:83], v[48:51], v[208:211]
    ds_read_b64_tr_b16 v[72:73], v4 offset:16384
    v_mfma_f32_16x16x32_bf16 v[180:183], v[48:51], v[100:103], v[180:183]
    ds_read_b64_tr_b16 v[74:75], v4 offset:16896
    v_mfma_f32_16x16x32_bf16 v[176:179], v[48:51], v[96:99], v[176:179]
    ds_read_b64_tr_b16 v[76:77], v5 offset:16384
    v_mfma_f32_16x16x32_bf16 v[140:143], v[92:95], v[48:51], v[140:143]
    ds_read_b64_tr_b16 v[78:79], v5 offset:16896
    v_mfma_f32_16x16x32_bf16 v[136:139], v[88:91], v[48:51], v[136:139]
    v_mfma_f32_16x16x32_bf16 v[144:147], v[88:91], v[52:55], v[144:147]
    v_mfma_f32_16x16x32_bf16 v[148:151], v[92:95], v[52:55], v[148:151]
    v_mfma_f32_16x16x32_bf16 v[184:187], v[52:55], v[96:99], v[184:187]
    v_mfma_f32_16x16x32_bf16 v[188:191], v[52:55], v[100:103], v[188:191]
    s_waitcnt lgkmcnt(0)
    v_mfma_f32_16x16x32_bf16 v[112:115], v[64:67], v[16:19], v[112:115]
    ds_read_b128 v[36:39], v3 offset:0
    v_mfma_f32_16x16x32_bf16 v[116:119], v[68:71], v[16:19], v[116:119]
    ds_read_b128 v[40:43], v3 offset:2048
    v_mfma_f32_16x16x32_bf16 v[152:155], v[16:19], v[72:75], v[152:155]
    ds_read_b128 v[44:47], v3 offset:4096
    v_mfma_f32_16x16x32_bf16 v[156:159], v[16:19], v[76:79], v[156:159]
    ds_read_b128 v[48:51], v3 offset:6144
    v_mfma_f32_16x16x32_bf16 v[196:199], v[60:63], v[20:23], v[196:199]
    ds_read_b128 v[52:55], v3 offset:8192
    v_mfma_f32_16x16x32_bf16 v[192:195], v[56:59], v[20:23], v[192:195]
    ds_read_b64_tr_b16 v[80:81], v4 offset:4096
    v_mfma_f32_16x16x32_bf16 v[164:167], v[20:23], v[76:79], v[164:167]
    ds_read_b64_tr_b16 v[82:83], v4 offset:4608
    v_mfma_f32_16x16x32_bf16 v[160:163], v[20:23], v[72:75], v[160:163]
    ds_read_b64_tr_b16 v[84:85], v5 offset:4096
    v_mfma_f32_16x16x32_bf16 v[124:127], v[68:71], v[20:23], v[124:127]
    ds_read_b64_tr_b16 v[86:87], v5 offset:4608
    v_mfma_f32_16x16x32_bf16 v[120:123], v[64:67], v[20:23], v[120:123]
    ds_read_b64_tr_b16 v[88:89], v4 offset:12288
    v_mfma_f32_16x16x32_bf16 v[128:131], v[64:67], v[24:27], v[128:131]
    ds_read_b64_tr_b16 v[90:91], v4 offset:12800
    v_mfma_f32_16x16x32_bf16 v[132:135], v[68:71], v[24:27], v[132:135]
    ds_read_b64_tr_b16 v[92:93], v5 offset:12288
    v_mfma_f32_16x16x32_bf16 v[168:171], v[24:27], v[72:75], v[168:171]
    ds_read_b64_tr_b16 v[94:95], v5 offset:12800
    v_mfma_f32_16x16x32_bf16 v[172:175], v[24:27], v[76:79], v[172:175]
    ds_read_b64_tr_b16 v[96:97], v4 offset:20480
    v_mfma_f32_16x16x32_bf16 v[200:203], v[56:59], v[24:27], v[200:203]
    ds_read_b64_tr_b16 v[98:99], v4 offset:20992
    v_mfma_f32_16x16x32_bf16 v[204:207], v[60:63], v[24:27], v[204:207]
    ds_read_b64_tr_b16 v[100:101], v5 offset:20480
    v_mfma_f32_16x16x32_bf16 v[212:215], v[60:63], v[28:31], v[212:215]
    ds_read_b64_tr_b16 v[102:103], v5 offset:20992
    v_mfma_f32_16x16x32_bf16 v[208:211], v[56:59], v[28:31], v[208:211]
    v_mfma_f32_16x16x32_bf16 v[180:183], v[28:31], v[76:79], v[180:183]
    s_add_u32 s51, s51, 43008
    s_cmp_ge_u32 s51, 129024
    v_mfma_f32_16x16x32_bf16 v[176:179], v[28:31], v[72:75], v[176:179]
    s_cselect_b32 s51, 0, s51
    v_mfma_f32_16x16x32_bf16 v[140:143], v[68:71], v[28:31], v[140:143]
    s_cselect_b32 s53, s54, s55
    v_mfma_f32_16x16x32_bf16 v[136:139], v[64:67], v[28:31], v[136:139]
    v_add_u32 v2, s53, v2
    v_mfma_f32_16x16x32_bf16 v[144:147], v[64:67], v[32:35], v[144:147]
    v_add_u32 v3, s53, v3
    v_mfma_f32_16x16x32_bf16 v[148:151], v[68:71], v[32:35], v[148:151]
    v_add_u32 v4, s53, v4
    v_mfma_f32_16x16x32_bf16 v[184:187], v[32:35], v[72:75], v[184:187]
    v_add_u32 v5, s53, v5
    v_mfma_f32_16x16x32_bf16 v[188:191], v[32:35], v[76:79], v[188:191]
    s_sub_u32 s52, s52, 1
    s_cbranch_scc0 cloop_1
    s_waitcnt lgkmcnt(0)
    v_mfma_f32_16x16x32_bf16 v[144:147], v[88:91], v[52:55], v[144:147]
    v_mfma_f32_16x16x32_bf16 v[148:151], v[92:95], v[52:55], v[148:151]
    v_mfma_f32_16x16x32_bf16 v[184:187], v[52:55], v[96:99], v[184:187]
    v_mfma_f32_16x16x32_bf16 v[188:191], v[52:55], v[100:103], v[188:191]
    s_barrier
    v_mfma_f32_16x16x32_bf16 v[112:115], v[88:91], v[36:39], v[112:115]
    ds_read_b64 v[10:11], v7 offset:0
    ds_read_b64 v[12:13], v7 offset:128
    v_mfma_f32_16x16x32_bf16 v[116:119], v[92:95], v[36:39], v[116:119]
    ds_read_b64 v[14:15], v7 offset:256
    v_mfma_f32_16x16x32_bf16 v[152:155], v[36:39], v[96:99], v[152:155]
    ds_read_b64 v[104:105], v7 offset:384
    v_mfma_f32_16x16x32_bf16 v[156:159], v[36:39], v[100:103], v[156:159]
    ds_read_b64 v[106:107], v7 offset:512
    v_mfma_f32_16x16x32_bf16 v[196:199], v[84:87], v[40:43], v[196:199]
    ds_read_b128 v[108:111], v8 offset:256
    v_mfma_f32_16x16x32_bf16 v[192:195], v[80:83], v[40:43], v[192:195]
    ds_read_b128 v[244:247], v8 offset:320
    v_mfma_f32_16x16x32_bf16 v[164:167], v[40:43], v[100:103], v[164:167]
    ds_read_b128 v[248:251], v8 offset:0
    v_mfma_f32_16x16x32_bf16 v[160:163], v[40:43], v[96:99], v[160:163]
    ds_read_b128 v[76:79], v8 offset:64
    v_mfma_f32_16x16x32_bf16 v[124:127], v[92:95], v[40:43], v[124:127]
    ds_read_b32 v236, v6 offset:512
    v_mfma_f32_16x16x32_bf16 v[120:123], v[88:91], v[40:43], v[120:123]
    ds_read_b32 v238, v6 offset:576
    ds_read_b128 v[16:19], v9 offset:0
    v_mfma_f32_16x16x32_bf16 v[128:131], v[88:91], v[44:47], v[128:131]
    ds_read_b128 v[20:23], v9 offset:64
    v_mfma_f32_16x16x32_bf16 v[132:135], v[92:95], v[44:47], v[132:135]
    ds_read_b128 v[24:27], v9 offset:128
    v_mfma_f32_16x16x32_bf16 v[168:171], v[44:47], v[96:99], v[168:171]
    ds_read_b128 v[28:31], v9 offset:192
    v_mfma_f32_16x16x32_bf16 v[172:175], v[44:47], v[100:103], v[172:175]
    ds_read_b128 v[32:35], v9 offset:256
    v_mfma_f32_16x16x32_bf16 v[200:203], v[80:83], v[44:47], v[200:203]
    ds_read_b128 v[56:59], v9 offset:576
    v_mfma_f32_16x16x32_bf16 v[204:207], v[84:87], v[44:47], v[204:207]
    ds_read_b128 v[60:63], v9 offset:640
    v_mfma_f32_16x16x32_bf16 v[212:215], v[84:87], v[48:51], v[212:215]
    ds_read_b128 v[64:67], v9 offset:704
    v_mfma_f32_16x16x32_bf16 v[208:211], v[80:83], v[48:51], v[208:211]
    ds_read_b128 v[68:71], v9 offset:768
    v_mfma_f32_16x16x32_bf16 v[180:183], v[48:51], v[100:103], v[180:183]
    ds_read_b128 v[72:75], v9 offset:832
    v_mfma_f32_16x16x32_bf16 v[176:179], v[48:51], v[96:99], v[176:179]
    v_mfma_f32_16x16x32_bf16 v[140:143], v[92:95], v[48:51], v[140:143]
    v_mfma_f32_16x16x32_bf16 v[136:139], v[88:91], v[48:51], v[136:139]
    v_lshlrev_b32 v2, 4, v0
    v_add_u32 v3, s84, v2
    s_waitcnt lgkmcnt(0)
    v_pk_fma_f32 v[144:145], v[106:107], v[108:109], v[144:145] op_sel:[1,0,0] op_sel_hi:[1,1,1] neg_lo:[1,0,0] neg_hi:[1,0,0]
    v_pk_fma_f32 v[146:147], v[106:107], v[110:111], v[146:147] op_sel:[1,0,0] op_sel_hi:[1,1,1] neg_lo:[1,0,0] neg_hi:[1,0,0]
    v_pk_fma_f32 v[148:149], v[106:107], v[244:245], v[148:149] op_sel:[1,0,0] op_sel_hi:[1,1,1] neg_lo:[1,0,0] neg_hi:[1,0,0]
    v_pk_fma_f32 v[150:151], v[106:107], v[246:247], v[150:151] op_sel:[1,0,0] op_sel_hi:[1,1,1] neg_lo:[1,0,0] neg_hi:[1,0,0]
    v_pk_fma_f32 v[184:185], v[32:33], v[236:237], v[184:185] op_sel_hi:[1,0,1] neg_lo:[1,0,0] neg_hi:[1,0,0]
    v_pk_fma_f32 v[186:187], v[34:35], v[236:237], v[186:187] op_sel_hi:[1,0,1] neg_lo:[1,0,0] neg_hi:[1,0,0]
    v_pk_fma_f32 v[188:189], v[32:33], v[238:239], v[188:189] op_sel_hi:[1,0,1] neg_lo:[1,0,0] neg_hi:[1,0,0]
    v_pk_fma_f32 v[190:191], v[34:35], v[238:239], v[190:191] op_sel_hi:[1,0,1] neg_lo:[1,0,0] neg_hi:[1,0,0]
    v_pk_mul_f32 v[184:185], v[184:185], v[72:73]
    v_pk_mul_f32 v[186:187], v[186:187], v[74:75]
    v_pk_mul_f32 v[188:189], v[188:189], v[72:73]
    v_pk_mul_f32 v[190:191], v[190:191], v[74:75]
    v_pk_mul_f32 v[144:145], v[144:145], v[106:107] op_sel_hi:[1,0]
    v_pk_mul_f32 v[146:147], v[146:147], v[106:107] op_sel_hi:[1,0]
    v_pk_mul_f32 v[148:149], v[148:149], v[106:107] op_sel_hi:[1,0]
    v_pk_mul_f32 v[150:151], v[150:151], v[106:107] op_sel_hi:[1,0]
    v_cvt_pk_bf16_f32 v96, v184, v185
    v_cvt_pk_bf16_f32 v97, v186, v187
    v_cvt_pk_bf16_f32 v98, v188, v189
    v_cvt_pk_bf16_f32 v99, v190, v191
    v_cvt_pk_bf16_f32 v52, v144, v145
    v_cvt_pk_bf16_f32 v53, v146, v147
    v_cvt_pk_bf16_f32 v54, v148, v149
    v_cvt_pk_bf16_f32 v55, v150, v151
    ds_write_b128 v3, v[96:99] offset:1024
    ds_write_b128 v3, v[52:55]
    v_pk_fma_f32 v[112:113], v[10:11], v[108:109], v[112:113] op_sel:[1,0,0] op_sel_hi:[1,1,1] neg_lo:[1,0,0] neg_hi:[1,0,0]
    v_pk_fma_f32 v[114:115], v[10:11], v[110:111], v[114:115] op_sel:[1,0,0] op_sel_hi:[1,1,1] neg_lo:[1,0,0] neg_hi:[1,0,0]
    v_pk_fma_f32 v[116:117], v[10:11], v[244:245], v[116:117] op_sel:[1,0,0] op_sel_hi:[1,1,1] neg_lo:[1,0,0] neg_hi:[1,0,0]
    v_pk_fma_f32 v[118:119], v[10:11], v[246:247], v[118:119] op_sel:[1,0,0] op_sel_hi:[1,1,1] neg_lo:[1,0,0] neg_hi:[1,0,0]
    v_pk_fma_f32 v[120:121], v[12:13], v[108:109], v[120:121] op_sel:[1,0,0] op_sel_hi:[1,1,1] neg_lo:[1,0,0] neg_hi:[1,0,0]
    v_pk_fma_f32 v[122:123], v[12:13], v[110:111], v[122:123] op_sel:[1,0,0] op_sel_hi:[1,1,1] neg_lo:[1,0,0] neg_hi:[1,0,0]
    v_pk_fma_f32 v[124:125], v[12:13], v[244:245], v[124:125] op_sel:[1,0,0] op_sel_hi:[1,1,1] neg_lo:[1,0,0] neg_hi:[1,0,0]
    v_pk_fma_f32 v[126:127], v[12:13], v[246:247], v[126:127] op_sel:[1,0,0] op_sel_hi:[1,1,1] neg_lo:[1,0,0] neg_hi:[1,0,0]
    v_mov_b32 v4, s85
    v_mov_b32 v5, 1
    s_waitcnt lgkmcnt(0)
    ds_write_b32 v4, v5
    v_pk_fma_f32 v[128:129], v[14:15], v[108:109], v[128:129] op_sel:[1,0,0] op_sel_hi:[1,1,1] neg_lo:[1,0,0] neg_hi:[1,0,0]
    v_pk_fma_f32 v[130:131], v[14:15], v[110:111], v[130:131] op_sel:[1,0,0] op_sel_hi:[1,1,1] neg_lo:[1,0,0] neg_hi:[1,0,0]
    v_pk_fma_f32 v[132:133], v[14:15], v[244:245], v[132:133] op_sel:[1,0,0] op_sel_hi:[1,1,1] neg_lo:[1,0,0] neg_hi:[1,0,0]
    v_pk_fma_f32 v[134:135], v[14:15], v[246:247], v[134:135] op_sel:[1,0,0] op_sel_hi:[1,1,1] neg_lo:[1,0,0] neg_hi:[1,0,0]
    v_pk_fma_f32 v[136:137], v[104:105], v[108:109], v[136:137] op_sel:[1,0,0] op_sel_hi:[1,1,1] neg_lo:[1,0,0] neg_hi:[1,0,0]
    v_pk_fma_f32 v[138:139], v[104:105], v[110:111], v[138:139] op_sel:[1,0,0] op_sel_hi:[1,1,1] neg_lo:[1,0,0] neg_hi:[1,0,0]
    v_pk_fma_f32 v[140:141], v[104:105], v[244:245], v[140:141] op_sel:[1,0,0] op_sel_hi:[1,1,1] neg_lo:[1,0,0] neg_hi:[1,0,0]
    v_pk_fma_f32 v[142:143], v[104:105], v[246:247], v[142:143] op_sel:[1,0,0] op_sel_hi:[1,1,1] neg_lo:[1,0,0] neg_hi:[1,0,0]
    v_pk_fma_f32 v[192:193], v[12:13], v[248:249], v[192:193] op_sel:[1,0,0] op_sel_hi:[1,1,1] neg_lo:[1,0,0] neg_hi:[1,0,0]
    v_pk_fma_f32 v[194:195], v[12:13], v[250:251], v[194:195] op_sel:[1,0,0] op_sel_hi:[1,1,1] neg_lo:[1,0,0] neg_hi:[1,0,0]
    v_pk_fma_f32 v[196:197], v[12:13], v[76:77], v[196:197] op_sel:[1,0,0] op_sel_hi:[1,1,1] neg_lo:[1,0,0] neg_hi:[1,0,0]
    v_pk_fma_f32 v[198:199], v[12:13], v[78:79], v[198:199] op_sel:[1,0,0] op_sel_hi:[1,1,1] neg_lo:[1,0,0] neg_hi:[1,0,0]
    v_pk_fma_f32 v[200:201], v[14:15], v[248:249], v[200:201] op_sel:[1,0,0] op_sel_hi:[1,1,1] neg_lo:[1,0,0] neg_hi:[1,0,0]
    v_pk_fma_f32 v[202:203], v[14:15], v[250:251], v[202:203] op_sel:[1,0,0] op_sel_hi:[1,1,1] neg_lo:[1,0,0] neg_hi:[1,0,0]
    v_pk_fma_f32 v[204:205], v[14:15], v[76:77], v[204:205] op_sel:[1,0,0] op_sel_hi:[1,1,1] neg_lo:[1,0,0] neg_hi:[1,0,0]
    v_pk_fma_f32 v[206:207], v[14:15], v[78:79], v[206:207] op_sel:[1,0,0] op_sel_hi:[1,1,1] neg_lo:[1,0,0] neg_hi:[1,0,0]
    v_pk_fma_f32 v[208:209], v[104:105], v[248:249], v[208:209] op_sel:[1,0,0] op_sel_hi:[1,1,1] neg_lo:[1,0,0] neg_hi:[1,0,0]
    v_pk_fma_f32 v[210:211], v[104:105], v[250:251], v[210:211] op_sel:[1,0,0] op_sel_hi:[1,1,1] neg_lo:[1,0,0] neg_hi:[1,0,0]
    v_pk_fma_f32 v[212:213], v[104:105], v[76:77], v[212:213] op_sel:[1,0,0] op_sel_hi:[1,1,1] neg_lo:[1,0,0] neg_hi:[1,0,0]
    v_pk_fma_f32 v[214:215], v[104:105], v[78:79], v[214:215] op_sel:[1,0,0] op_sel_hi:[1,1,1] neg_lo:[1,0,0] neg_hi:[1,0,0]
    v_pk_mul_f32 v[112:113], v[112:113], v[10:11] op_sel_hi:[1,0]
    v_pk_mul_f32 v[114:115], v[114:115], v[10:11] op_sel_hi:[1,0]
    v_pk_mul_f32 v[116:117], v[116:117], v[10:11] op_sel_hi:[1,0]
    v_pk_mul_f32 v[118:119], v[118:119], v[10:11] op_sel_hi:[1,0]
    v_pk_mul_f32 v[120:121], v[120:121], v[12:13] op_sel_hi:[1,0]
    v_pk_mul_f32 v[122:123], v[122:123], v[12:13] op_sel_hi:[1,0]
    v_pk_mul_f32 v[124:125], v[124:125], v[12:13] op_sel_hi:[1,0]
    v_pk_mul_f32 v[126:127], v[126:127], v[12:13] op_sel_hi:[1,0]
    v_pk_mul_f32 v[128:129], v[128:129], v[14:15] op_sel_hi:[1,0]
    v_pk_mul_f32 v[130:131], v[130:131], v[14:15] op_sel_hi:[1,0]
    v_pk_mul_f32 v[132:133], v[132:133], v[14:15] op_sel_hi:[1,0]
    v_pk_mul_f32 v[134:135], v[134:135], v[14:15] op_sel_hi:[1,0]
    v_pk_mul_f32 v[136:137], v[136:137], v[104:105] op_sel_hi:[1,0]
    v_pk_mul_f32 v[138:139], v[138:139], v[104:105] op_sel_hi:[1,0]
    v_pk_mul_f32 v[140:141], v[140:141], v[104:105] op_sel_hi:[1,0]
    v_pk_mul_f32 v[142:143], v[142:143], v[104:105] op_sel_hi:[1,0]
    v_mul_f32 v240, 0x3e8293ee, v12
    v_mul_f32 v241, 0x3e8293ee, v14
    v_mul_f32 v242, 0x3e8293ee, v104
    v_mul_f32 v243, 0x3e8293ee, v106
    v_cvt_pk_bf16_f32 v36, v112, v113
    v_cvt_pk_bf16_f32 v37, v114, v115
    v_cvt_pk_bf16_f32 v38, v116, v117
    v_cvt_pk_bf16_f32 v39, v118, v119
    v_cvt_pk_bf16_f32 v40, v120, v121
    v_cvt_pk_bf16_f32 v41, v122, v123
    v_cvt_pk_bf16_f32 v42, v124, v125
    v_cvt_pk_bf16_f32 v43, v126, v127
    v_cvt_pk_bf16_f32 v44, v128, v129
    v_cvt_pk_bf16_f32 v45, v130, v131
    v_cvt_pk_bf16_f32 v46, v132, v133
    v_cvt_pk_bf16_f32 v47, v134, v135
    v_cvt_pk_bf16_f32 v48, v136, v137
    v_cvt_pk_bf16_f32 v49, v138, v139
    v_cvt_pk_bf16_f32 v50, v140, v141
    v_cvt_pk_bf16_f32 v51, v142, v143
    v_cvt_pk_bf16_f32 v80, v192, v193
    v_cvt_pk_bf16_f32 v81, v194, v195
    v_cvt_pk_bf16_f32 v82, v196, v197
    v_cvt_pk_bf16_f32 v83, v198, v199
    v_cvt_pk_bf16_f32 v84, v200, v201
    v_cvt_pk_bf16_f32 v85, v202, v203
    v_cvt_pk_bf16_f32 v86, v204, v205
    v_cvt_pk_bf16_f32 v87, v206, v207
    v_cvt_pk_bf16_f32 v88, v208, v209
    v_cvt_pk_bf16_f32 v89, v210, v211
    v_cvt_pk_bf16_f32 v90, v212, v213
    v_cvt_pk_bf16_f32 v91, v214, v215
    v_pk_fma_f32 v[152:153], v[16:17], v[236:237], v[152:153] op_sel_hi:[1,0,1] neg_lo:[1,0,0] neg_hi:[1,0,0]
    v_pk_fma_f32 v[154:155], v[18:19], v[236:237], v[154:155] op_sel_hi:[1,0,1] neg_lo:[1,0,0] neg_hi:[1,0,0]
    v_pk_fma_f32 v[156:157], v[16:17], v[238:239], v[156:157] op_sel_hi:[1,0,1] neg_lo:[1,0,0] neg_hi:[1,0,0]
    v_pk_fma_f32 v[158:159], v[18:19], v[238:239], v[158:159] op_sel_hi:[1,0,1] neg_lo:[1,0,0] neg_hi:[1,0,0]
    v_pk_fma_f32 v[160:161], v[20:21], v[236:237], v[160:161] op_sel_hi:[1,0,1] neg_lo:[1,0,0] neg_hi:[1,0,0]
    v_pk_fma_f32 v[162:163], v[22:23], v[236:237], v[162:163] op_sel_hi:[1,0,1] neg_lo:[1,0,0] neg_hi:[1,0,0]
    v_pk_fma_f32 v[164:165], v[20:21], v[238:239], v[164:165] op_sel_hi:[1,0,1] neg_lo:[1,0,0] neg_hi:[1,0,0]
    v_pk_fma_f32 v[166:167], v[22:23], v[238:239], v[166:167] op_sel_hi:[1,0,1] neg_lo:[1,0,0] neg_hi:[1,0,0]
    v_pk_fma_f32 v[168:169], v[24:25], v[236:237], v[168:169] op_sel_hi:[1,0,1] neg_lo:[1,0,0] neg_hi:[1,0,0]
    v_pk_fma_f32 v[170:171], v[26:27], v[236:237], v[170:171] op_sel_hi:[1,0,1] neg_lo:[1,0,0] neg_hi:[1,0,0]
    v_pk_fma_f32 v[172:173], v[24:25], v[238:239], v[172:173] op_sel_hi:[1,0,1] neg_lo:[1,0,0] neg_hi:[1,0,0]
    v_pk_fma_f32 v[174:175], v[26:27], v[238:239], v[174:175] op_sel_hi:[1,0,1] neg_lo:[1,0,0] neg_hi:[1,0,0]
    v_pk_fma_f32 v[176:177], v[28:29], v[236:237], v[176:177] op_sel_hi:[1,0,1] neg_lo:[1,0,0] neg_hi:[1,0,0]
    v_pk_fma_f32 v[178:179], v[30:31], v[236:237], v[178:179] op_sel_hi:[1,0,1] neg_lo:[1,0,0] neg_hi:[1,0,0]
    v_pk_fma_f32 v[180:181], v[28:29], v[238:239], v[180:181] op_sel_hi:[1,0,1] neg_lo:[1,0,0] neg_hi:[1,0,0]
    v_pk_fma_f32 v[182:183], v[30:31], v[238:239], v[182:183] op_sel_hi:[1,0,1] neg_lo:[1,0,0] neg_hi:[1,0,0]
    v_pk_mul_f32 v[152:153], v[152:153], v[56:57]
    v_pk_mul_f32 v[154:155], v[154:155], v[58:59]
    v_pk_mul_f32 v[156:157], v[156:157], v[56:57]
    v_pk_mul_f32 v[158:159], v[158:159], v[58:59]
    v_pk_mul_f32 v[160:161], v[160:161], v[60:61]
    v_pk_mul_f32 v[162:163], v[162:163], v[62:63]
    v_pk_mul_f32 v[164:165], v[164:165], v[60:61]
    v_pk_mul_f32 v[166:167], v[166:167], v[62:63]
    v_pk_mul_f32 v[168:169], v[168:169], v[64:65]
    v_pk_mul_f32 v[170:171], v[170:171], v[66:67]
    v_pk_mul_f32 v[172:173], v[172:173], v[64:65]
    v_pk_mul_f32 v[174:175], v[174:175], v[66:67]
    v_pk_mul_f32 v[176:177], v[176:177], v[68:69]
    v_pk_mul_f32 v[178:179], v[178:179], v[70:71]
    v_pk_mul_f32 v[180:181], v[180:181], v[68:69]
    v_pk_mul_f32 v[182:183], v[182:183], v[70:71]
    v_cvt_pk_bf16_f32 v16, v152, v153
    v_cvt_pk_bf16_f32 v17, v154, v155
    v_cvt_pk_bf16_f32 v26, v156, v157
    v_cvt_pk_bf16_f32 v27, v158, v159
    v_mov_b32 v4, s86
xw_2:
    ds_read_b32 v5, v4
    s_waitcnt lgkmcnt(0)
    v_cmp_ne_u32 vcc, 1, v5
    s_cbranch_vccnz xw_2
    ds_read_b128 v[92:95], v3 offset:2048
    s_branch L_att
L_rh1:
    s_mov_b32 s51, 0
    s_mov_b32 s52, 14
    s_mov_b32 s54, 0xfffeb000
    s_mov_b32 s55, 43008
    s_barrier
    ds_read_b128 v[16:19], v2 offset:0
    ds_read_b128 v[20:23], v2 offset:2048
    ds_read_b128 v[24:27], v2 offset:4096
    ds_read_b128 v[28:31], v2 offset:6144
    ds_read_b128 v[32:35], v2 offset:8192
    ds_read_b64_tr_b16 v[56:57], v4 offset:0
    ds_read_b64_tr_b16 v[58:59], v4 offset:512
    ds_read_b64_tr_b16 v[60:61], v5 offset:0
    ds_read_b64_tr_b16 v[62:63], v5 offset:512
    ds_read_b64_tr_b16 v[64:65], v4 offset:8192
    ds_read_b64_tr_b16 v[66:67], v4 offset:8704
    ds_read_b64_tr_b16 v[68:69], v5 offset:8192
    ds_read_b64_tr_b16 v[70:71], v5 offset:8704
    ds_read_b64_tr_b16 v[72:73], v4 offset:16384
    ds_read_b64_tr_b16 v[74:75], v4 offset:16896
    ds_read_b64_tr_b16 v[76:77], v5 offset:16384
    ds_read_b64_tr_b16 v[78:79], v5 offset:16896
    s_waitcnt lgkmcnt(0)
    v_mfma_f32_16x16x32_bf16 v[112:115], v[56:59], v[16:19], 0
    ds_read_b128 v[36:39], v3 offset:0
    v_mfma_f32_16x16x32_bf16 v[116:119], v[60:63], v[16:19], 0
    ds_read_b128 v[40:43], v3 offset:2048
    v_mfma_f32_16x16x32_bf16 v[196:199], v[60:63], v[20:23], 0
    ds_read_b128 v[44:47], v3 offset:4096
    v_mfma_f32_16x16x32_bf16 v[192:195], v[56:59], v[20:23], 0
    ds_read_b128 v[48:51], v3 offset:6144
    v_mfma_f32_16x16x32_bf16 v[164:167], v[20:23], v[76:79], 0
    ds_read_b128 v[52:55], v3 offset:8192
    v_mfma_f32_16x16x32_bf16 v[160:163], v[20:23], v[72:75], 0
    ds_read_b64_tr_b16 v[80:81], v4 offset:4096
    v_mfma_f32_16x16x32_bf16 v[124:127], v[68:71], v[20:23], 0
    ds_read_b64_tr_b16 v[82:83], v4 offset:4608
    v_mfma_f32_16x16x32_bf16 v[120:123], v[64:67], v[20:23], 0
    ds_read_b64_tr_b16 v[84:85], v5 offset:4096
    v_mfma_f32_16x16x32_bf16 v[128:131], v[64:67], v[24:27], 0
    ds_read_b64_tr_b16 v[86:87], v5 offset:4608
    v_mfma_f32_16x16x32_bf16 v[132:135], v[68:71], v[24:27], 0
    ds_read_b64_tr_b16 v[88:89], v4 offset:12288
    v_mfma_f32_16x16x32_bf16 v[168:171], v[24:27], v[72:75], 0
    ds_read_b64_tr_b16 v[90:91], v4 offset:12800
    v_mfma_f32_16x16x32_bf16 v[172:175], v[24:27], v[76:79], 0
    ds_read_b64_tr_b16 v[92:93], v5 offset:12288
    v_mfma_f32_16x16x32_bf16 v[200:203], v[56:59], v[24:27], 0
    ds_read_b64_tr_b16 v[94:95], v5 offset:12800
    v_mfma_f32_16x16x32_bf16 v[204:207], v[60:63], v[24:27], 0
    ds_read_b64_tr_b16 v[96:97], v4 offset:20480
    v_mfma_f32_16x16x32_bf16 v[212:215], v[60:63], v[28:31], 0
    ds_read_b64_tr_b16 v[98:99], v4 offset:20992
    v_mfma_f32_16x16x32_bf16 v[208:211], v[56:59], v[28:31], 0
    ds_read_b64_tr_b16 v[100:101], v5 offset:20480
    v_mfma_f32_16x16x32_bf16 v[180:183], v[28:31], v[76:79], 0
    ds_read_b64_tr_b16 v[102:103], v5 offset:20992
    v_mfma_f32_16x16x32_bf16 v[176:179], v[28:31], v[72:75], 0
    v_mfma_f32_16x16x32_bf16 v[140:143], v[68:71], v[28:31], 0
    s_add_u32 s51, s51, 43008
    s_cmp_ge_u32 s51, 129024
    v_mfma_f32_16x16x32_bf16 v[136:139], v[64:67], v[28:31], 0
    s_cselect_b32 s51, 0, s51
    v_mfma_f32_16x16x32_bf16 v[144:147], v[64:67], v[32:35], 0
    s_cselect_b32 s53, s54, s55
    v_mfma_f32_16x16x32_bf16 v[148:151], v[68:71], v[32:35], 0
    v_add_u32 v2, s53, v2
    v_mfma_f32_16x16x32_bf16 v[184:187], v[32:35], v[72:75], 0
    v_add_u32 v3, s53, v3
    v_mfma_f32_16x16x32_bf16 v[188:191], v[32:35], v[76:79], 0
    v_add_u32 v4, s53, v4
    v_mfma_f32_16x16x32_bf16 v[216:219], v[56:59], v[32:35], 0
    v_add_u32 v5, s53, v5
    v_mfma_f32_16x16x32_bf16 v[220:223], v[60:63], v[32:35], 0
cloop_3:
    s_waitcnt lgkmcnt(0)
    v_mfma_f32_16x16x32_bf16 v[112:115], v[80:83], v[36:39], v[112:115]
    v_mfma_f32_16x16x32_bf16 v[116:119], v[84:87], v[36:39], v[116:119]
    v_mfma_f32_16x16x32_bf16 v[196:199], v[84:87], v[40:43], v[196:199]
    v_mfma_f32_16x16x32_bf16 v[192:195], v[80:83], v[40:43], v[192:195]
    s_barrier
    v_mfma_f32_16x16x32_bf16 v[164:167], v[40:43], v[100:103], v[164:167]
    ds_read_b128 v[16:19], v2 offset:0
    v_mfma_f32_16x16x32_bf16 v[160:163], v[40:43], v[96:99], v[160:163]
    ds_read_b128 v[20:23], v2 offset:2048
    v_mfma_f32_16x16x32_bf16 v[124:127], v[92:95], v[40:43], v[124:127]
    ds_read_b128 v[24:27], v2 offset:4096
    v_mfma_f32_16x16x32_bf16 v[120:123], v[88:91], v[40:43], v[120:123]
    ds_read_b128 v[28:31], v2 offset:6144
    v_mfma_f32_16x16x32_bf16 v[128:131], v[88:91], v[44:47], v[128:131]
    ds_read_b128 v[32:35], v2 offset:8192
    v_mfma_f32_16x16x32_bf16 v[132:135], v[92:95], v[44:47], v[132:135]
    ds_read_b64_tr_b16 v[56:57], v4 offset:0
    v_mfma_f32_16x16x32_bf16 v[168:171], v[44:47], v[96:99], v[168:171]
    ds_read_b64_tr_b16 v[58:59], v4 offset:512
    v_mfma_f32_16x16x32_bf16 v[172:175], v[44:47], v[100:103], v[172:175]
    ds_read_b64_tr_b16 v[60:61], v5 offset:0
    v_mfma_f32_16x16x32_bf16 v[200:203], v[80:83], v[44:47], v[200:203]
    ds_read_b64_tr_b16 v[62:63], v5 offset:512
    v_mfma_f32_16x16x32_bf16 v[204:207], v[84:87], v[44:47], v[204:207]
    ds_read_b64_tr_b16 v[64:65], v4 offset:8192
    v_mfma_f32_16x16x32_bf16 v[212:215], v[84:87], v[48:51], v[212:215]
    ds_read_b64_tr_b16 v[66:67], v4 offset:8704
    v_mfma_f32_16x16x32_bf16 v[208:211], v[80:83], v[48:51], v[208:211]
    ds_read_b64_tr_b16 v[68:69], v5 offset:8192
    v_mfma_f32_16x16x32_bf16 v[180:183], v[48:51], v[100:103], v[180:183]
    ds_read_b64_tr_b16 v[70:71], v5 offset:8704
    v_mfma_f32_16x16x32_bf16 v[176:179], v[48:51], v[96:99], v[176:179]
    ds_read_b64_tr_b16 v[72:73], v4 offset:16384
    v_mfma_f32_16x16x32_bf16 v[140:143], v[92:95], v[48:51], v[140:143]
    ds_read_b64_tr_b16 v[74:75], v4 offset:16896
    v_mfma_f32_16x16x32_bf16 v[136:139], v[88:91], v[48:51], v[136:139]
    ds_read_b64_tr_b16 v[76:77], v5 offset:16384
    v_mfma_f32_16x16x32_bf16 v[144:147], v[88:91], v[52:55], v[144:147]
    ds_read_b64_tr_b16 v[78:79], v5 offset:16896
    v_mfma_f32_16x16x32_bf16 v[148:151], v[92:95], v[52:55], v[148:151]
    v_mfma_f32_16x16x32_bf16 v[184:187], v[52:55], v[96:99], v[184:187]
    v_mfma_f32_16x16x32_bf16 v[188:191], v[52:55], v[100:103], v[188:191]
    v_mfma_f32_16x16x32_bf16 v[216:219], v[80:83], v[52:55], v[216:219]
    v_mfma_f32_16x16x32_bf16 v[220:223], v[84:87], v[52:55], v[220:223]
    s_waitcnt lgkmcnt(0)
    v_mfma_f32_16x16x32_bf16 v[112:115], v[56:59], v[16:19], v[112:115]
    ds_read_b128 v[36:39], v3 offset:0
    v_mfma_f32_16x16x32_bf16 v[116:119], v[60:63], v[16:19], v[116:119]
    ds_read_b128 v[40:43], v3 offset:2048
    v_mfma_f32_16x16x32_bf16 v[196:199], v[60:63], v[20:23], v[196:199]
    ds_read_b128 v[44:47], v3 offset:4096
    v_mfma_f32_16x16x32_bf16 v[192:195], v[56:59], v[20:23], v[192:195]
    ds_read_b128 v[48:51], v3 offset:6144
    v_mfma_f32_16x16x32_bf16 v[164:167], v[20:23], v[76:79], v[164:167]
    ds_read_b128 v[52:55], v3 offset:8192
    v_mfma_f32_16x16x32_bf16 v[160:163], v[20:23], v[72:75], v[160:163]
    ds_read_b64_tr_b16 v[80:81], v4 offset:4096
    v_mfma_f32_16x16x32_bf16 v[124:127], v[68:71], v[20:23], v[124:127]
    ds_read_b64_tr_b16 v[82:83], v4 offset:4608
    v_mfma_f32_16x16x32_bf16 v[120:123], v[64:67], v[20:23], v[120:123]
    ds_read_b64_tr_b16 v[84:85], v5 offset:4096
    v_mfma_f32_16x16x32_bf16 v[128:131], v[64:67], v[24:27], v[128:131]
    ds_read_b64_tr_b16 v[86:87], v5 offset:4608
    v_mfma_f32_16x16x32_bf16 v[132:135], v[68:71], v[24:27], v[132:135]
    ds_read_b64_tr_b16 v[88:89], v4 offset:12288
    v_mfma_f32_16x16x32_bf16 v[168:171], v[24:27], v[72:75], v[168:171]
    ds_read_b64_tr_b16 v[90:91], v4 offset:12800
    v_mfma_f32_16x16x32_bf16 v[172:175], v[24:27], v[76:79], v[172:175]
    ds_read_b64_tr_b16 v[92:93], v5 offset:12288
    v_mfma_f32_16x16x32_bf16 v[200:203], v[56:59], v[24:27], v[200:203]
    ds_read_b64_tr_b16 v[94:95], v5 offset:12800
    v_mfma_f32_16x16x32_bf16 v[204:207], v[60:63], v[24:27], v[204:207]
    ds_read_b64_tr_b16 v[96:97], v4 offset:20480
    v_mfma_f32_16x16x32_bf16 v[212:215], v[60:63], v[28:31], v[212:215]
    ds_read_b64_tr_b16 v[98:99], v4 offset:20992
    v_mfma_f32_16x16x32_bf16 v[208:211], v[56:59], v[28:31], v[208:211]
    ds_read_b64_tr_b16 v[100:101], v5 offset:20480
    v_mfma_f32_16x16x32_bf16 v[180:183], v[28:31], v[76:79], v[180:183]
    ds_read_b64_tr_b16 v[102:103], v5 offset:20992
    v_mfma_f32_16x16x32_bf16 v[176:179], v[28:31], v[72:75], v[176:179]
    v_mfma_f32_16x16x32_bf16 v[140:143], v[68:71], v[28:31], v[140:143]
    s_add_u32 s51, s51, 43008
    s_cmp_ge_u32 s51, 129024
    v_mfma_f32_16x16x32_bf16 v[136:139], v[64:67], v[28:31], v[136:139]
    s_cselect_b32 s51, 0, s51
    v_mfma_f32_16x16x32_bf16 v[144:147], v[64:67], v[32:35], v[144:147]
    s_cselect_b32 s53, s54, s55
    v_mfma_f32_16x16x32_bf16 v[148:151], v[68:71], v[32:35], v[148:151]
    v_add_u32 v2, s53, v2
    v_mfma_f32_16x16x32_bf16 v[184:187], v[32:35], v[72:75], v[184:187]
    v_add_u32 v3, s53, v3
    v_mfma_f32_16x16x32_bf16 v[188:191], v[32:35], v[76:79], v[188:191]
    v_add_u32 v4, s53, v4
    v_mfma_f32_16x16x32_bf16 v[216:219], v[56:59], v[32:35], v[216:219]
    v_add_u32 v5, s53, v5
    v_mfma_f32_16x16x32_bf16 v[220:223], v[60:63], v[32:35], v[220:223]
    s_sub_u32 s52, s52, 1
    s_cbranch_scc0 cloop_3
    s_waitcnt lgkmcnt(0)
    v_mfma_f32_16x16x32_bf16 v[112:115], v[80:83], v[36:39], v[112:115]
    v_mfma_f32_16x16x32_bf16 v[116:119], v[84:87], v[36:39], v[116:119]
    v_mfma_f32_16x16x32_bf16 v[196:199], v[84:87], v[40:43], v[196:199]
    v_mfma_f32_16x16x32_bf16 v[192:195], v[80:83], v[40:43], v[192:195]
    s_barrier
    v_mfma_f32_16x16x32_bf16 v[164:167], v[40:43], v[100:103], v[164:167]
    ds_read_b64 v[10:11], v7 offset:0
    v_mfma_f32_16x16x32_bf16 v[160:163], v[40:43], v[96:99], v[160:163]
    ds_read_b64 v[12:13], v7 offset:128
    v_mfma_f32_16x16x32_bf16 v[124:127], v[92:95], v[40:43], v[124:127]
    ds_read_b64 v[14:15], v7 offset:256
    v_mfma_f32_16x16x32_bf16 v[120:123], v[88:91], v[40:43], v[120:123]
    ds_read_b64 v[104:105], v7 offset:384
    v_mfma_f32_16x16x32_bf16 v[128:131], v[88:91], v[44:47], v[128:131]
    ds_read_b64 v[106:107], v7 offset:512
    v_mfma_f32_16x16x32_bf16 v[132:135], v[92:95], v[44:47], v[132:135]
    ds_read_b128 v[108:111], v8 offset:256
    v_mfma_f32_16x16x32_bf16 v[168:171], v[44:47], v[96:99], v[168:171]
    ds_read_b128 v[244:247], v8 offset:320
    v_mfma_f32_16x16x32_bf16 v[172:175], v[44:47], v[100:103], v[172:175]
    ds_read_b128 v[248:251], v8 offset:0
    v_mfma_f32_16x16x32_bf16 v[200:203], v[80:83], v[44:47], v[200:203]
    ds_read_b128 v[76:79], v8 offset:64
    v_mfma_f32_16x16x32_bf16 v[204:207], v[84:87], v[44:47], v[204:207]
    ds_read_b32 v236, v6 offset:512
    v_mfma_f32_16x16x32_bf16 v[212:215], v[84:87], v[48:51], v[212:215]
    ds_read_b32 v238, v6 offset:576
    v_mfma_f32_16x16x32_bf16 v[208:211], v[80:83], v[48:51], v[208:211]
    ds_read_b128 v[20:23], v9 offset:64
    v_mfma_f32_16x16x32_bf16 v[180:183], v[48:51], v[100:103], v[180:183]
    ds_read_b128 v[24:27], v9 offset:128
    v_mfma_f32_16x16x32_bf16 v[176:179], v[48:51], v[96:99], v[176:179]
    ds_read_b128 v[28:31], v9 offset:192
    v_mfma_f32_16x16x32_bf16 v[140:143], v[92:95], v[48:51], v[140:143]
    ds_read_b128 v[32:35], v9 offset:256
    v_mfma_f32_16x16x32_bf16 v[136:139], v[88:91], v[48:51], v[136:139]
    ds_read_b128 v[60:63], v9 offset:640
    v_mfma_f32_16x16x32_bf16 v[144:147], v[88:91], v[52:55], v[144:147]
    ds_read_b128 v[64:67], v9 offset:704
    v_mfma_f32_16x16x32_bf16 v[148:151], v[92:95], v[52:55], v[148:151]
    ds_read_b128 v[68:71], v9 offset:768
    v_mfma_f32_16x16x32_bf16 v[184:187], v[52:55], v[96:99], v[184:187]
    ds_read_b128 v[72:75], v9 offset:832
    v_mfma_f32_16x16x32_bf16 v[188:191], v[52:55], v[100:103], v[188:191]
    v_mfma_f32_16x16x32_bf16 v[216:219], v[80:83], v[52:55], v[216:219]
    v_mfma_f32_16x16x32_bf16 v[220:223], v[84:87], v[52:55], v[220:223]
    v_lshlrev_b32 v2, 4, v0
    v_add_u32 v3, s84, v2
    s_waitcnt lgkmcnt(0)
    v_pk_fma_f32 v[112:113], v[10:11], v[248:249], v[112:113] op_sel:[1,0,0] op_sel_hi:[1,1,1] neg_lo:[1,0,0] neg_hi:[1,0,0]
    v_pk_fma_f32 v[114:115], v[10:11], v[250:251], v[114:115] op_sel:[1,0,0] op_sel_hi:[1,1,1] neg_lo:[1,0,0] neg_hi:[1,0,0]
    v_pk_fma_f32 v[116:117], v[10:11], v[76:77], v[116:117] op_sel:[1,0,0] op_sel_hi:[1,1,1] neg_lo:[1,0,0] neg_hi:[1,0,0]
    v_pk_fma_f32 v[118:119], v[10:11], v[78:79], v[118:119] op_sel:[1,0,0] op_sel_hi:[1,1,1] neg_lo:[1,0,0] neg_hi:[1,0,0]
    v_pk_fma_f32 v[120:121], v[12:13], v[108:109], v[120:121] op_sel:[1,0,0] op_sel_hi:[1,1,1] neg_lo:[1,0,0] neg_hi:[1,0,0]
    v_pk_fma_f32 v[122:123], v[12:13], v[110:111], v[122:123] op_sel:[1,0,0] op_sel_hi:[1,1,1] neg_lo:[1,0,0] neg_hi:[1,0,0]
    v_pk_fma_f32 v[124:125], v[12:13], v[244:245], v[124:125] op_sel:[1,0,0] op_sel_hi:[1,1,1] neg_lo:[1,0,0] neg_hi:[1,0,0]
    v_pk_fma_f32 v[126:127], v[12:13], v[246:247], v[126:127] op_sel:[1,0,0] op_sel_hi:[1,1,1] neg_lo:[1,0,0] neg_hi:[1,0,0]
    v_cvt_pk_bf16_f32 v96, v112, v113
    v_cvt_pk_bf16_f32 v97, v114, v115
    v_cvt_pk_bf16_f32 v98, v116, v117
    v_cvt_pk_bf16_f32 v99, v118, v119
    ds_write_b128 v3, v[96:99] offset:2048
    v_pk_fma_f32 v[128:129], v[14:15], v[108:109], v[128:129] op_sel:[1,0,0] op_sel_hi:[1,1,1] neg_lo:[1,0,0] neg_hi:[1,0,0]
    v_pk_fma_f32 v[130:131], v[14:15], v[110:111], v[130:131] op_sel:[1,0,0] op_sel_hi:[1,1,1] neg_lo:[1,0,0] neg_hi:[1,0,0]
    v_pk_fma_f32 v[132:133], v[14:15], v[244:245], v[132:133] op_sel:[1,0,0] op_sel_hi:[1,1,1] neg_lo:[1,0,0] neg_hi:[1,0,0]
    v_pk_fma_f32 v[134:135], v[14:15], v[246:247], v[134:135] op_sel:[1,0,0] op_sel_hi:[1,1,1] neg_lo:[1,0,0] neg_hi:[1,0,0]
    v_mov_b32 v4, s85
    v_mov_b32 v5, 1
    s_waitcnt lgkmcnt(0)
    ds_write_b32 v4, v5
    v_pk_fma_f32 v[136:137], v[104:105], v[108:109], v[136:137] op_sel:[1,0,0] op_sel_hi:[1,1,1] neg_lo:[1,0,0] neg_hi:[1,0,0]
    v_pk_fma_f32 v[138:139], v[104:105], v[110:111], v[138:139] op_sel:[1,0,0] op_sel_hi:[1,1,1] neg_lo:[1,0,0] neg_hi:[1,0,0]
    v_pk_fma_f32 v[140:141], v[104:105], v[244:245], v[140:141] op_sel:[1,0,0] op_sel_hi:[1,1,1] neg_lo:[1,0,0] neg_hi:[1,0,0]
    v_pk_fma_f32 v[142:143], v[104:105], v[246:247], v[142:143] op_sel:[1,0,0] op_sel_hi:[1,1,1] neg_lo:[1,0,0] neg_hi:[1,0,0]
    v_pk_fma_f32 v[144:145], v[106:107], v[108:109], v[144:145] op_sel:[1,0,0] op_sel_hi:[1,1,1] neg_lo:[1,0,0] neg_hi:[1,0,0]
    v_pk_fma_f32 v[146:147], v[106:107], v[110:111], v[146:147] op_sel:[1,0,0] op_sel_hi:[1,1,1] neg_lo:[1,0,0] neg_hi:[1,0,0]
    v_pk_fma_f32 v[148:149], v[106:107], v[244:245], v[148:149] op_sel:[1,0,0] op_sel_hi:[1,1,1] neg_lo:[1,0,0] neg_hi:[1,0,0]
    v_pk_fma_f32 v[150:151], v[106:107], v[246:247], v[150:151] op_sel:[1,0,0] op_sel_hi:[1,1,1] neg_lo:[1,0,0] neg_hi:[1,0,0]
    v_pk_fma_f32 v[192:193], v[12:13], v[248:249], v[192:193] op_sel:[1,0,0] op_sel_hi:[1,1,1] neg_lo:[1,0,0] neg_hi:[1,0,0]
    v_pk_fma_f32 v[194:195], v[12:13], v[250:251], v[194:195] op_sel:[1,0,0] op_sel_hi:[1,1,1] neg_lo:[1,0,0] neg_hi:[1,0,0]
    v_pk_fma_f32 v[196:197], v[12:13], v[76:77], v[196:197] op_sel:[1,0,0] op_sel_hi:[1,1,1] neg_lo:[1,0,0] neg_hi:[1,0,0]
    v_pk_fma_f32 v[198:199], v[12:13], v[78:79], v[198:199] op_sel:[1,0,0] op_sel_hi:[1,1,1] neg_lo:[1,0,0] neg_hi:[1,0,0]
    v_pk_fma_f32 v[200:201], v[14:15], v[248:249], v[200:201] op_sel:[1,0,0] op_sel_hi:[1,1,1] neg_lo:[1,0,0] neg_hi:[1,0,0]
    v_pk_fma_f32 v[202:203], v[14:15], v[250:251], v[202:203] op_sel:[1,0,0] op_sel_hi:[1,1,1] neg_lo:[1,0,0] neg_hi:[1,0,0]
    v_pk_fma_f32 v[204:205], v[14:15], v[76:77], v[204:205] op_sel:[1,0,0] op_sel_hi:[1,1,1] neg_lo:[1,0,0] neg_hi:[1,0,0]
    v_pk_fma_f32 v[206:207], v[14:15], v[78:79], v[206:207] op_sel:[1,0,0] op_sel_hi:[1,1,1] neg_lo:[1,0,0] neg_hi:[1,0,0]
    v_pk_fma_f32 v[208:209], v[104:105], v[248:249], v[208:209] op_sel:[1,0,0] op_sel_hi:[1,1,1] neg_lo:[1,0,0] neg_hi:[1,0,0]
    v_pk_fma_f32 v[210:211], v[104:105], v[250:251], v[210:211] op_sel:[1,0,0] op_sel_hi:[1,1,1] neg_lo:[1,0,0] neg_hi:[1,0,0]
    v_pk_fma_f32 v[212:213], v[104:105], v[76:77], v[212:213] op_sel:[1,0,0] op_sel_hi:[1,1,1] neg_lo:[1,0,0] neg_hi:[1,0,0]
    v_pk_fma_f32 v[214:215], v[104:105], v[78:79], v[214:215] op_sel:[1,0,0] op_sel_hi:[1,1,1] neg_lo:[1,0,0] neg_hi:[1,0,0]
    v_pk_fma_f32 v[216:217], v[106:107], v[248:249], v[216:217] op_sel:[1,0,0] op_sel_hi:[1,1,1] neg_lo:[1,0,0] neg_hi:[1,0,0]
    v_pk_fma_f32 v[218:219], v[106:107], v[250:251], v[218:219] op_sel:[1,0,0] op_sel_hi:[1,1,1] neg_lo:[1,0,0] neg_hi:[1,0,0]
    v_pk_fma_f32 v[220:221], v[106:107], v[76:77], v[220:221] op_sel:[1,0,0] op_sel_hi:[1,1,1] neg_lo:[1,0,0] neg_hi:[1,0,0]
    v_pk_fma_f32 v[222:223], v[106:107], v[78:79], v[222:223] op_sel:[1,0,0] op_sel_hi:[1,1,1] neg_lo:[1,0,0] neg_hi:[1,0,0]
    v_pk_mul_f32 v[120:121], v[120:121], v[12:13] op_sel_hi:[1,0]
    v_pk_mul_f32 v[122:123], v[122:123], v[12:13] op_sel_hi:[1,0]
    v_pk_mul_f32 v[124:125], v[124:125], v[12:13] op_sel_hi:[1,0]
    v_pk_mul_f32 v[126:127], v[126:127], v[12:13] op_sel_hi:[1,0]
    v_pk_mul_f32 v[128:129], v[128:129], v[14:15] op_sel_hi:[1,0]
    v_pk_mul_f32 v[130:131], v[130:131], v[14:15] op_sel_hi:[1,0]
    v_pk_mul_f32 v[132:133], v[132:133], v[14:15] op_sel_hi:[1,0]
    v_pk_mul_f32 v[134:135], v[134:135], v[14:15] op_sel_hi:[1,0]
    v_pk_mul_f32 v[136:137], v[136:137], v[104:105] op_sel_hi:[1,0]
    v_pk_mul_f32 v[138:139], v[138:139], v[104:105] op_sel_hi:[1,0]
    v_pk_mul_f32 v[140:141], v[140:141], v[104:105] op_sel_hi:[1,0]
    v_pk_mul_f32 v[142:143], v[142:143], v[104:105] op_sel_hi:[1,0]
    v_pk_mul_f32 v[144:145], v[144:145], v[106:107] op_sel_hi:[1,0]
    v_pk_mul_f32 v[146:147], v[146:147], v[106:107] op_sel_hi:[1,0]
    v_pk_mul_f32 v[148:149], v[148:149], v[106:107] op_sel_hi:[1,0]
    v_pk_mul_f32 v[150:151], v[150:151], v[106:107] op_sel_hi:[1,0]
    v_mul_f32 v240, 0x3e8293ee, v12
    v_mul_f32 v241, 0x3e8293ee, v14
    v_mul_f32 v242, 0x3e8293ee, v104
    v_mul_f32 v243, 0x3e8293ee, v106
    v_cvt_pk_bf16_f32 v40, v120, v121
    v_cvt_pk_bf16_f32 v41, v122, v123
    v_cvt_pk_bf16_f32 v42, v124, v125
    v_cvt_pk_bf16_f32 v43, v126, v127
    v_cvt_pk_bf16_f32 v44, v128, v129
    v_cvt_pk_bf16_f32 v45, v130, v131
    v_cvt_pk_bf16_f32 v46, v132, v133
    v_cvt_pk_bf16_f32 v47, v134, v135
    v_cvt_pk_bf16_f32 v48, v136, v137
    v_cvt_pk_bf16_f32 v49, v138, v139
    v_cvt_pk_bf16_f32 v50, v140, v141
    v_cvt_pk_bf16_f32 v51, v142, v143
    v_cvt_pk_bf16_f32 v52, v144, v145
    v_cvt_pk_bf16_f32 v53, v146, v147
    v_cvt_pk_bf16_f32 v54, v148, v149
    v_cvt_pk_bf16_f32 v55, v150, v151
    v_cvt_pk_bf16_f32 v80, v192, v193
    v_cvt_pk_bf16_f32 v81, v194, v195
    v_cvt_pk_bf16_f32 v82, v196, v197
    v_cvt_pk_bf16_f32 v83, v198, v199
    v_cvt_pk_bf16_f32 v84, v200, v201
    v_cvt_pk_bf16_f32 v85, v202, v203
    v_cvt_pk_bf16_f32 v86, v204, v205
    v_cvt_pk_bf16_f32 v87, v206, v207
    v_cvt_pk_bf16_f32 v88, v208, v209
    v_cvt_pk_bf16_f32 v89, v210, v211
    v_cvt_pk_bf16_f32 v90, v212, v213
    v_cvt_pk_bf16_f32 v91, v214, v215
    v_cvt_pk_bf16_f32 v92, v216, v217
    v_cvt_pk_bf16_f32 v93, v218, v219
    v_cvt_pk_bf16_f32 v94, v220, v221
    v_cvt_pk_bf16_f32 v95, v222, v223
    v_pk_fma_f32 v[160:161], v[20:21], v[236:237], v[160:161] op_sel_hi:[1,0,1] neg_lo:[1,0,0] neg_hi:[1,0,0]
    v_pk_fma_f32 v[162:163], v[22:23], v[236:237], v[162:163] op_sel_hi:[1,0,1] neg_lo:[1,0,0] neg_hi:[1,0,0]
    v_pk_fma_f32 v[164:165], v[20:21], v[238:239], v[164:165] op_sel_hi:[1,0,1] neg_lo:[1,0,0] neg_hi:[1,0,0]
    v_pk_fma_f32 v[166:167], v[22:23], v[238:239], v[166:167] op_sel_hi:[1,0,1] neg_lo:[1,0,0] neg_hi:[1,0,0]
    v_pk_fma_f32 v[168:169], v[24:25], v[236:237], v[168:169] op_sel_hi:[1,0,1] neg_lo:[1,0,0] neg_hi:[1,0,0]
    v_pk_fma_f32 v[170:171], v[26:27], v[236:237], v[170:171] op_sel_hi:[1,0,1] neg_lo:[1,0,0] neg_hi:[1,0,0]
    v_pk_fma_f32 v[172:173], v[24:25], v[238:239], v[172:173] op_sel_hi:[1,0,1] neg_lo:[1,0,0] neg_hi:[1,0,0]
    v_pk_fma_f32 v[174:175], v[26:27], v[238:239], v[174:175] op_sel_hi:[1,0,1] neg_lo:[1,0,0] neg_hi:[1,0,0]
    v_pk_fma_f32 v[176:177], v[28:29], v[236:237], v[176:177] op_sel_hi:[1,0,1] neg_lo:[1,0,0] neg_hi:[1,0,0]
    v_pk_fma_f32 v[178:179], v[30:31], v[236:237], v[178:179] op_sel_hi:[1,0,1] neg_lo:[1,0,0] neg_hi:[1,0,0]
    v_pk_fma_f32 v[180:181], v[28:29], v[238:239], v[180:181] op_sel_hi:[1,0,1] neg_lo:[1,0,0] neg_hi:[1,0,0]
    v_pk_fma_f32 v[182:183], v[30:31], v[238:239], v[182:183] op_sel_hi:[1,0,1] neg_lo:[1,0,0] neg_hi:[1,0,0]
    v_pk_fma_f32 v[184:185], v[32:33], v[236:237], v[184:185] op_sel_hi:[1,0,1] neg_lo:[1,0,0] neg_hi:[1,0,0]
    v_pk_fma_f32 v[186:187], v[34:35], v[236:237], v[186:187] op_sel_hi:[1,0,1] neg_lo:[1,0,0] neg_hi:[1,0,0]
    v_pk_fma_f32 v[188:189], v[32:33], v[238:239], v[188:189] op_sel_hi:[1,0,1] neg_lo:[1,0,0] neg_hi:[1,0,0]
    v_pk_fma_f32 v[190:191], v[34:35], v[238:239], v[190:191] op_sel_hi:[1,0,1] neg_lo:[1,0,0] neg_hi:[1,0,0]
    v_pk_mul_f32 v[160:161], v[160:161], v[60:61]
    v_pk_mul_f32 v[162:163], v[162:163], v[62:63]
    v_pk_mul_f32 v[164:165], v[164:165], v[60:61]
    v_pk_mul_f32 v[166:167], v[166:167], v[62:63]
    v_pk_mul_f32 v[168:169], v[168:169], v[64:65]
    v_pk_mul_f32 v[170:171], v[170:171], v[66:67]
    v_pk_mul_f32 v[172:173], v[172:173], v[64:65]
    v_pk_mul_f32 v[174:175], v[174:175], v[66:67]
    v_pk_mul_f32 v[176:177], v[176:177], v[68:69]
    v_pk_mul_f32 v[178:179], v[178:179], v[70:71]
    v_pk_mul_f32 v[180:181], v[180:181], v[68:69]
    v_pk_mul_f32 v[182:183], v[182:183], v[70:71]
    v_pk_mul_f32 v[184:185], v[184:185], v[72:73]
    v_pk_mul_f32 v[186:187], v[186:187], v[74:75]
    v_pk_mul_f32 v[188:189], v[188:189], v[72:73]
    v_pk_mul_f32 v[190:191], v[190:191], v[74:75]
    v_mov_b32 v4, s86
xw_4:
    ds_read_b32 v5, v4
    s_waitcnt lgkmcnt(0)
    v_cmp_ne_u32 vcc, 1, v5
    s_cbranch_vccnz xw_4
    ds_read_b128 v[36:39], v3
    ds_read_b64 v[16:17], v3 offset:1024
    ds_read_b64 v[26:27], v3 offset:1032
L_att:
    s_add_u32 s36, s24, 4194304
    s_addc_u32 s37, s25, 0
    s_mov_b32 s38, 4194304
    s_mov_b32 s39, 0x20000
    s_waitcnt lgkmcnt(0)
    v_mfma_f32_16x16x32_bf16 v[120:123], v[40:43], v[84:87], v[224:227]
    v_mfma_f32_16x16x32_bf16 v[124:127], v[44:47], v[84:87], v[228:231]
    v_mfma_f32_16x16x32_bf16 v[128:131], v[44:47], v[88:91], v[224:227]
    v_mfma_f32_16x16x32_bf16 v[132:135], v[48:51], v[88:91], v[228:231]
    v_mfma_f32_16x16x32_bf16 v[112:115], v[36:39], v[80:83], v[232:235]
    v_mfma_f32_16x16x32_bf16 v[116:119], v[40:43], v[80:83], v[228:231]
    v_mfma_f32_16x16x32_bf16 v[136:139], v[48:51], v[92:95], v[224:227]
    v_mfma_f32_16x16x32_bf16 v[140:143], v[52:55], v[92:95], v[228:231]
    v_cvt_pk_bf16_f32 v18, v160, v161
    v_cvt_pk_bf16_f32 v19, v162, v163
    v_cvt_pk_bf16_f32 v28, v164, v165
    v_cvt_pk_bf16_f32 v29, v166, v167
    v_cvt_pk_bf16_f32 v20, v168, v169
    v_cvt_pk_bf16_f32 v21, v170, v171
    v_cvt_pk_bf16_f32 v30, v172, v173
    v_cvt_pk_bf16_f32 v31, v174, v175
    v_cvt_pk_bf16_f32 v22, v176, v177
    v_cvt_pk_bf16_f32 v23, v178, v179
    v_cvt_pk_bf16_f32 v32, v180, v181
    v_cvt_pk_bf16_f32 v33, v182, v183
    v_cvt_pk_bf16_f32 v24, v184, v185
    v_cvt_pk_bf16_f32 v25, v186, v187
    v_cvt_pk_bf16_f32 v34, v188, v189
    v_cvt_pk_bf16_f32 v35, v190, v191
    v_max3_f32 v144, v112, v113, v114
    v_max3_f32 v145, v115, v116, v117
    v_max3_f32 v146, v120, v121, v122
    v_max3_f32 v147, v123, v124, v125
    v_max3_f32 v148, v128, v129, v130
    v_max3_f32 v149, v131, v132, v133
    v_max3_f32 v150, v136, v137, v138
    v_max3_f32 v151, v139, v140, v141
    v_max3_f32 v144, v144, v118, v119
    v_max3_f32 v146, v146, v126, v127
    v_max3_f32 v148, v148, v134, v135
    v_max3_f32 v150, v150, v142, v143
    v_max_f32 v144, v144, v145
    v_max_f32 v146, v146, v147
    v_max_f32 v148, v148, v149
    v_max_f32 v150, v150, v151
    v_mov_b32 v145, v144
    v_mov_b32 v147, v146
    v_mov_b32 v149, v148
    v_mov_b32 v151, v150
    v_permlane16_swap_b32 v145, v144
    v_permlane16_swap_b32 v147, v146
    v_permlane16_swap_b32 v149, v148
    v_permlane16_swap_b32 v151, v150
    v_max_f32 v144, v145, v144
    v_max_f32 v146, v147, v146
    v_max_f32 v148, v149, v148
    v_max_f32 v150, v151, v150
    v_mov_b32 v145, v144
    v_mov_b32 v147, v146
    v_mov_b32 v149, v148
    v_mov_b32 v151, v150
    v_permlane32_swap_b32 v145, v144
    v_permlane32_swap_b32 v147, v146
    v_permlane32_swap_b32 v149, v148
    v_permlane32_swap_b32 v151, v150
    v_max_f32 v144, v145, v144
    v_max_f32 v146, v147, v146
    v_max_f32 v148, v149, v148
    v_max_f32 v150, v151, v150
    v_mul_f32 v144, v240, v144
    v_mul_f32 v146, v241, v146
    v_mul_f32 v148, v242, v148
    v_mul_f32 v150, v243, v150
    v_pk_fma_f32 v[112:113], v[112:113], v[240:241], v[144:145] op_sel:[0,0,0] op_sel_hi:[1,0,0] neg_lo:[0,0,1] neg_hi:[0,0,1]
    v_pk_fma_f32 v[120:121], v[120:121], v[240:241], v[146:147] op_sel:[0,1,0] op_sel_hi:[1,1,0] neg_lo:[0,0,1] neg_hi:[0,0,1]
    v_pk_fma_f32 v[128:129], v[128:129], v[242:243], v[148:149] op_sel:[0,0,0] op_sel_hi:[1,0,0] neg_lo:[0,0,1] neg_hi:[0,0,1]
    v_pk_fma_f32 v[136:137], v[136:137], v[242:243], v[150:151] op_sel:[0,1,0] op_sel_hi:[1,1,0] neg_lo:[0,0,1] neg_hi:[0,0,1]
    v_pk_fma_f32 v[114:115], v[114:115], v[240:241], v[144:145] op_sel:[0,0,0] op_sel_hi:[1,0,0] neg_lo:[0,0,1] neg_hi:[0,0,1]
    v_pk_fma_f32 v[122:123], v[122:123], v[240:241], v[146:147] op_sel:[0,1,0] op_sel_hi:[1,1,0] neg_lo:[0,0,1] neg_hi:[0,0,1]
    v_pk_fma_f32 v[130:131], v[130:131], v[242:243], v[148:149] op_sel:[0,0,0] op_sel_hi:[1,0,0] neg_lo:[0,0,1] neg_hi:[0,0,1]
    v_pk_fma_f32 v[138:139], v[138:139], v[242:243], v[150:151] op_sel:[0,1,0] op_sel_hi:[1,1,0] neg_lo:[0,0,1] neg_hi:[0,0,1]
    v_pk_fma_f32 v[116:117], v[116:117], v[240:241], v[144:145] op_sel:[0,0,0] op_sel_hi:[1,0,0] neg_lo:[0,0,1] neg_hi:[0,0,1]
    v_pk_fma_f32 v[124:125], v[124:125], v[240:241], v[146:147] op_sel:[0,1,0] op_sel_hi:[1,1,0] neg_lo:[0,0,1] neg_hi:[0,0,1]
    v_pk_fma_f32 v[132:133], v[132:133], v[242:243], v[148:149] op_sel:[0,0,0] op_sel_hi:[1,0,0] neg_lo:[0,0,1] neg_hi:[0,0,1]
    v_pk_fma_f32 v[140:141], v[140:141], v[242:243], v[150:151] op_sel:[0,1,0] op_sel_hi:[1,1,0] neg_lo:[0,0,1] neg_hi:[0,0,1]
    v_pk_fma_f32 v[118:119], v[118:119], v[240:241], v[144:145] op_sel:[0,0,0] op_sel_hi:[1,0,0] neg_lo:[0,0,1] neg_hi:[0,0,1]
    v_pk_fma_f32 v[126:127], v[126:127], v[240:241], v[146:147] op_sel:[0,1,0] op_sel_hi:[1,1,0] neg_lo:[0,0,1] neg_hi:[0,0,1]
    v_pk_fma_f32 v[134:135], v[134:135], v[242:243], v[148:149] op_sel:[0,0,0] op_sel_hi:[1,0,0] neg_lo:[0,0,1] neg_hi:[0,0,1]
    v_pk_fma_f32 v[142:143], v[142:143], v[242:243], v[150:151] op_sel:[0,1,0] op_sel_hi:[1,1,0] neg_lo:[0,0,1] neg_hi:[0,0,1]
    v_exp_f32 v112, v112
    v_exp_f32 v113, v113
    v_exp_f32 v114, v114
    v_exp_f32 v115, v115
    v_exp_f32 v116, v116
    v_exp_f32 v117, v117
    v_exp_f32 v118, v118
    v_exp_f32 v119, v119
    v_exp_f32 v120, v120
    v_exp_f32 v121, v121
    v_exp_f32 v122, v122
    v_exp_f32 v123, v123
    v_exp_f32 v124, v124
    v_exp_f32 v125, v125
    v_exp_f32 v126, v126
    v_exp_f32 v127, v127
    v_exp_f32 v128, v128
    v_exp_f32 v129, v129
    v_exp_f32 v130, v130
    v_exp_f32 v131, v131
    v_exp_f32 v132, v132
    v_exp_f32 v133, v133
    v_exp_f32 v134, v134
    v_exp_f32 v135, v135
    v_exp_f32 v136, v136
    v_exp_f32 v137, v137
    v_exp_f32 v138, v138
    v_exp_f32 v139, v139
    v_exp_f32 v140, v140
    v_exp_f32 v141, v141
    v_exp_f32 v142, v142
    v_exp_f32 v143, v143
    v_pk_add_f32 v[192:193], v[112:113], v[114:115]
    v_pk_add_f32 v[196:197], v[120:121], v[122:123]
    v_pk_add_f32 v[200:201], v[128:129], v[130:131]
    v_pk_add_f32 v[204:205], v[136:137], v[138:139]
    v_pk_add_f32 v[194:195], v[116:117], v[118:119]
    v_pk_add_f32 v[198:199], v[124:125], v[126:127]
    v_pk_add_f32 v[202:203], v[132:133], v[134:135]
    v_pk_add_f32 v[206:207], v[140:141], v[142:143]
    v_pk_add_f32 v[192:193], v[192:193], v[194:195]
    v_pk_add_f32 v[196:197], v[196:197], v[198:199]
    v_pk_add_f32 v[200:201], v[200:201], v[202:203]
    v_pk_add_f32 v[204:205], v[204:205], v[206:207]
    v_add_f32 v144, v192, v193
    v_add_f32 v146, v196, v197
    v_add_f32 v148, v200, v201
    v_add_f32 v150, v204, v205
    v_mov_b32 v145, v144
    v_mov_b32 v147, v146
    v_mov_b32 v149, v148
    v_mov_b32 v151, v150
    v_permlane16_swap_b32 v145, v144
    v_permlane16_swap_b32 v147, v146
    v_permlane16_swap_b32 v149, v148
    v_permlane16_swap_b32 v151, v150
    v_add_f32 v144, v145, v144
    v_add_f32 v146, v147, v146
    v_add_f32 v148, v149, v148
    v_add_f32 v150, v151, v150
    v_mov_b32 v145, v144
    v_mov_b32 v147, v146
    v_mov_b32 v149, v148
    v_mov_b32 v151, v150
    v_permlane32_swap_b32 v145, v144
    v_permlane32_swap_b32 v147, v146
    v_permlane32_swap_b32 v149, v148
    v_permlane32_swap_b32 v151, v150
    v_add_f32 v144, v145, v144
    v_add_f32 v146, v147, v146
    v_add_f32 v148, v149, v148
    v_add_f32 v150, v151, v150
    v_rcp_f32 v144, v144
    v_rcp_f32 v146, v146
    v_rcp_f32 v148, v148
    v_rcp_f32 v150, v150
    v_pk_mul_f32 v[112:113], v[112:113], v[144:145] op_sel_hi:[1,0]
    v_pk_mul_f32 v[114:115], v[114:115], v[144:145] op_sel_hi:[1,0]
    v_pk_mul_f32 v[116:117], v[116:117], v[144:145] op_sel_hi:[1,0]
    v_pk_mul_f32 v[118:119], v[118:119], v[144:145] op_sel_hi:[1,0]
    v_cvt_pk_bf16_f32 v208, v112, v113
    v_cvt_pk_bf16_f32 v209, v114, v115
    v_cvt_pk_bf16_f32 v210, v116, v117
    v_cvt_pk_bf16_f32 v211, v118, v119
    v_pk_mul_f32 v[120:121], v[120:121], v[146:147] op_sel_hi:[1,0]
    v_pk_mul_f32 v[122:123], v[122:123], v[146:147] op_sel_hi:[1,0]
    v_pk_mul_f32 v[124:125], v[124:125], v[146:147] op_sel_hi:[1,0]
    v_pk_mul_f32 v[126:127], v[126:127], v[146:147] op_sel_hi:[1,0]
    v_cvt_pk_bf16_f32 v212, v120, v121
    v_cvt_pk_bf16_f32 v213, v122, v123
    v_cvt_pk_bf16_f32 v214, v124, v125
    v_cvt_pk_bf16_f32 v215, v126, v127
    v_mfma_f32_16x16x32_bf16 v[152:155], v[16:19], v[208:211], 0
    v_mfma_f32_16x16x32_bf16 v[156:159], v[26:29], v[208:211], 0
    v_pk_mul_f32 v[128:129], v[128:129], v[148:149] op_sel_hi:[1,0]
    v_pk_mul_f32 v[130:131], v[130:131], v[148:149] op_sel_hi:[1,0]
    v_pk_mul_f32 v[132:133], v[132:133], v[148:149] op_sel_hi:[1,0]
    v_pk_mul_f32 v[134:135], v[134:135], v[148:149] op_sel_hi:[1,0]
    v_cvt_pk_bf16_f32 v216, v128, v129
    v_cvt_pk_bf16_f32 v217, v130, v131
    v_cvt_pk_bf16_f32 v218, v132, v133
    v_cvt_pk_bf16_f32 v219, v134, v135
    v_mfma_f32_16x16x32_bf16 v[160:163], v[18:21], v[212:215], 0
    v_mfma_f32_16x16x32_bf16 v[164:167], v[28:31], v[212:215], 0
    v_pk_mul_f32 v[136:137], v[136:137], v[150:151] op_sel_hi:[1,0]
    v_pk_mul_f32 v[138:139], v[138:139], v[150:151] op_sel_hi:[1,0]
    v_pk_mul_f32 v[140:141], v[140:141], v[150:151] op_sel_hi:[1,0]
    v_pk_mul_f32 v[142:143], v[142:143], v[150:151] op_sel_hi:[1,0]
    v_cvt_pk_bf16_f32 v220, v136, v137
    v_cvt_pk_bf16_f32 v221, v138, v139
    v_cvt_pk_bf16_f32 v222, v140, v141
    v_cvt_pk_bf16_f32 v223, v142, v143
    v_mfma_f32_16x16x32_bf16 v[168:171], v[20:23], v[216:219], 0
    v_mfma_f32_16x16x32_bf16 v[172:175], v[30:33], v[216:219], 0
    s_nop 1
    v_mfma_f32_16x16x32_bf16 v[176:179], v[22:25], v[220:223], 0
    v_mfma_f32_16x16x32_bf16 v[180:183], v[32:35], v[220:223], 0
    v_cvt_pk_bf16_f32 v112, v152, v153
    v_cvt_pk_bf16_f32 v113, v154, v155
    v_cvt_pk_bf16_f32 v114, v156, v157
    v_cvt_pk_bf16_f32 v115, v158, v159
    s_add_u32 s56, s87, 0
    buffer_store_dwordx4 v[112:115], v2, s[36:39], s56 offen sc1
    v_cvt_pk_bf16_f32 v116, v160, v161
    v_cvt_pk_bf16_f32 v117, v162, v163
    v_cvt_pk_bf16_f32 v118, v164, v165
    v_cvt_pk_bf16_f32 v119, v166, v167
    s_add_u32 s56, s87, 32768
    buffer_store_dwordx4 v[116:119], v2, s[36:39], s56 offen sc1
    v_cvt_pk_bf16_f32 v120, v168, v169
    v_cvt_pk_bf16_f32 v121, v170, v171
    v_cvt_pk_bf16_f32 v122, v172, v173
    v_cvt_pk_bf16_f32 v123, v174, v175
    s_add_u32 s56, s87, 65536
    buffer_store_dwordx4 v[120:123], v2, s[36:39], s56 offen sc1
    v_cvt_pk_bf16_f32 v124, v176, v177
    v_cvt_pk_bf16_f32 v125, v178, v179
    v_cvt_pk_bf16_f32 v126, v180, v181
    v_cvt_pk_bf16_f32 v127, v182, v183
    s_add_u32 s56, s87, 98304
    buffer_store_dwordx4 v[124:127], v2, s[36:39], s56 offen sc1
    s_lshl_b32 s63, s44, 7
    s_lshl_b32 s53, s45, 2
    s_add_u32 s63, s63, s53
    s_add_u32 s63, s63, 8192
    v_mov_b32 v236, 160260
    v_mov_b32 v237, 1
    v_mov_b32 v238, 0
    v_mov_b32 v239, s62
    s_mov_b64 exec, 1
    s_waitcnt vmcnt(0)
    ds_add_rtn_u32 v237, v236, v237
    s_waitcnt lgkmcnt(0)
    v_cmp_ne_u32 vcc, 3, v237
    s_cbranch_vccnz nopub_5
    buffer_store_dword v239, v238, s[96:99], s63 offen sc1
nopub_5:
    s_mov_b64 exec, -1
    s_barrier
    s_and_b32 s53, s2, 3
    s_lshl_b32 s53, s53, 2
    s_lshr_b32 s54, s2, 3
    s_and_b32 s55, s54, 3
    s_add_u32 s44, s53, s55
    s_bfe_u32 s53, s2, 0x10002
    s_lshl_b32 s53, s53, 3
    s_lshr_b32 s54, s2, 5
    s_add_u32 s45, s53, s54
    s_add_u32 s47, s44, s45
    s_and_b32 s47, s47, 3
    s_lshl_b32 s55, s27, 12
    v_lshlrev_b32 v2, 4, v0
    v_add_u32 v2, s55, v2
    v_lshrrev_b32 v10, 2, v0
    v_bfe_u32 v11, v0, 3, 2
    v_xor_b32 v11, 0, v11
    v_lshlrev_b32 v11, 5, v11
    v_lshlrev_b32 v10, 7, v10
    v_add_u32 v4, v10, v11
    v_and_b32 v10, 3, v0
    v_lshlrev_b32 v10, 3, v10
    v_add_u32 v4, v4, v10
    v_add_u32 v4, 16384, v4
    v_lshrrev_b32 v10, 2, v0
    v_bfe_u32 v11, v0, 3, 2
    v_xor_b32 v11, 1, v11
    v_lshlrev_b32 v11, 5, v11
    v_lshlrev_b32 v10, 7, v10
    v_add_u32 v5, v10, v11
    v_and_b32 v10, 3, v0
    v_lshlrev_b32 v10, 3, v10
    v_add_u32 v5, v5, v10
    v_add_u32 v5, 16384, v5
    v_lshrrev_b32 v10, 2, v0
    v_bfe_u32 v11, v0, 3, 2
    v_xor_b32 v11, 2, v11
    v_lshlrev_b32 v11, 5, v11
    v_lshlrev_b32 v10, 7, v10
    v_add_u32 v6, v10, v11
    v_and_b32 v10, 3, v0
    v_lshlrev_b32 v10, 3, v10
    v_add_u32 v6, v6, v10
    v_add_u32 v6, 16384, v6
    v_lshrrev_b32 v10, 2, v0
    v_bfe_u32 v11, v0, 3, 2
    v_xor_b32 v11, 3, v11
    v_lshlrev_b32 v11, 5, v11
    v_lshlrev_b32 v10, 7, v10
    v_add_u32 v7, v10, v11
    v_and_b32 v10, 3, v0
    v_lshlrev_b32 v10, 3, v10
    v_add_u32 v7, v7, v10
    v_add_u32 v7, 16384, v7
    s_mov_b32 s51, 0
    s_mov_b32 s52, 14
    s_mov_b32 s54, 0xfffe8000
    s_mov_b32 s55, 24576
    s_barrier
    ds_read_b128 v[16:19], v2 offset:0
    ds_read_b128 v[20:23], v2 offset:2048
    ds_read_b64_tr_b16 v[32:33], v4 offset:0
    ds_read_b64_tr_b16 v[34:35], v4 offset:2048
    ds_read_b64_tr_b16 v[36:37], v5 offset:0
    ds_read_b64_tr_b16 v[38:39], v5 offset:2048
    ds_read_b64_tr_b16 v[40:41], v6 offset:0
    ds_read_b64_tr_b16 v[42:43], v6 offset:2048
    ds_read_b64_tr_b16 v[44:45], v7 offset:0
    ds_read_b64_tr_b16 v[46:47], v7 offset:2048
    v_and_b32 v8, 15, v0
    v_lshrrev_b32 v9, 1, v8
    v_lshrrev_b32 v10, 5, v0
    v_xor_b32 v9, v9, v10
    v_lshlrev_b32 v9, 4, v9
    v_lshl_add_u32 v8, v8, 7, v9
    v_bfe_u32 v9, v0, 4, 1
    v_lshl_add_u32 v8, v9, 3, v8
    s_lshl_b32 s84, s27, 12
    s_add_u32 s84, s84, 122880
    v_add_u32 v8, s84, v8
    v_xor_b32 v9, 32, v8
    v_xor_b32 v10, 64, v8
    v_xor_b32 v11, 96, v8
    ds_read_b64 v[200:201], v8 offset:0
    ds_read_b64 v[202:203], v9 offset:0
    ds_read_b64 v[204:205], v10 offset:0
    ds_read_b64 v[206:207], v11 offset:0
    ds_read_b64 v[208:209], v8 offset:2048
    ds_read_b64 v[210:211], v9 offset:2048
    ds_read_b64 v[212:213], v10 offset:2048
    ds_read_b64 v[214:215], v11 offset:2048
    s_waitcnt lgkmcnt(0)
    v_mfma_f32_16x16x32_bf16 v[64:67], v[32:35], v[16:19], 0
    ds_read_b128 v[24:27], v2 offset:1024
    ds_read_b128 v[28:31], v2 offset:3072
    ds_read_b64_tr_b16 v[48:49], v4 offset:4096
    ds_read_b64_tr_b16 v[50:51], v4 offset:6144
    v_mfma_f32_16x16x32_bf16 v[68:71], v[36:39], v[16:19], 0
    ds_read_b64_tr_b16 v[52:53], v5 offset:4096
    ds_read_b64_tr_b16 v[54:55], v5 offset:6144
    ds_read_b64_tr_b16 v[56:57], v6 offset:4096
    v_mfma_f32_16x16x32_bf16 v[72:75], v[40:43], v[16:19], 0
    ds_read_b64_tr_b16 v[58:59], v6 offset:6144
    ds_read_b64_tr_b16 v[60:61], v7 offset:4096
    ds_read_b64_tr_b16 v[62:63], v7 offset:6144
    v_mfma_f32_16x16x32_bf16 v[76:79], v[44:47], v[16:19], 0
    s_add_u32 s51, s51, 24576
    s_cmp_ge_u32 s51, 122880
    s_cselect_b32 s51, 0, s51
    v_mfma_f32_16x16x32_bf16 v[92:95], v[44:47], v[20:23], 0
    s_cselect_b32 s53, s54, s55
    v_add_u32 v2, s53, v2
    v_mfma_f32_16x16x32_bf16 v[88:91], v[40:43], v[20:23], 0
    v_add_u32 v4, s53, v4
    v_add_u32 v5, s53, v5
    v_mfma_f32_16x16x32_bf16 v[84:87], v[36:39], v[20:23], 0
    v_add_u32 v6, s53, v6
    v_add_u32 v7, s53, v7
    v_mfma_f32_16x16x32_bf16 v[80:83], v[32:35], v[20:23], 0
cloop_6:
    s_waitcnt lgkmcnt(0)
    s_barrier
    v_mfma_f32_16x16x32_bf16 v[64:67], v[48:51], v[24:27], v[64:67]
    ds_read_b128 v[16:19], v2 offset:0
    ds_read_b128 v[20:23], v2 offset:2048
    v_mfma_f32_16x16x32_bf16 v[68:71], v[52:55], v[24:27], v[68:71]
    ds_read_b64_tr_b16 v[32:33], v4 offset:0
    v_mfma_f32_16x16x32_bf16 v[72:75], v[56:59], v[24:27], v[72:75]
    ds_read_b64_tr_b16 v[34:35], v4 offset:2048
    ds_read_b64_tr_b16 v[36:37], v5 offset:0
    v_mfma_f32_16x16x32_bf16 v[76:79], v[60:63], v[24:27], v[76:79]
    ds_read_b64_tr_b16 v[38:39], v5 offset:2048
    v_mfma_f32_16x16x32_bf16 v[92:95], v[60:63], v[28:31], v[92:95]
    ds_read_b64_tr_b16 v[40:41], v6 offset:0
    ds_read_b64_tr_b16 v[42:43], v6 offset:2048
    v_mfma_f32_16x16x32_bf16 v[88:91], v[56:59], v[28:31], v[88:91]
    ds_read_b64_tr_b16 v[44:45], v7 offset:0
    v_mfma_f32_16x16x32_bf16 v[84:87], v[52:55], v[28:31], v[84:87]
    ds_read_b64_tr_b16 v[46:47], v7 offset:2048
    v_mfma_f32_16x16x32_bf16 v[80:83], v[48:51], v[28:31], v[80:83]
    s_waitcnt lgkmcnt(0)
    v_mfma_f32_16x16x32_bf16 v[64:67], v[32:35], v[16:19], v[64:67]
    ds_read_b128 v[24:27], v2 offset:1024
    ds_read_b128 v[28:31], v2 offset:3072
    ds_read_b64_tr_b16 v[48:49], v4 offset:4096
    ds_read_b64_tr_b16 v[50:51], v4 offset:6144
    v_mfma_f32_16x16x32_bf16 v[68:71], v[36:39], v[16:19], v[68:71]
    ds_read_b64_tr_b16 v[52:53], v5 offset:4096
    ds_read_b64_tr_b16 v[54:55], v5 offset:6144
    ds_read_b64_tr_b16 v[56:57], v6 offset:4096
    v_mfma_f32_16x16x32_bf16 v[72:75], v[40:43], v[16:19], v[72:75]
    ds_read_b64_tr_b16 v[58:59], v6 offset:6144
    ds_read_b64_tr_b16 v[60:61], v7 offset:4096
    ds_read_b64_tr_b16 v[62:63], v7 offset:6144
    v_mfma_f32_16x16x32_bf16 v[76:79], v[44:47], v[16:19], v[76:79]
    s_add_u32 s51, s51, 24576
    s_cmp_ge_u32 s51, 122880
    s_cselect_b32 s51, 0, s51
    v_mfma_f32_16x16x32_bf16 v[92:95], v[44:47], v[20:23], v[92:95]
    s_cselect_b32 s53, s54, s55
    v_add_u32 v2, s53, v2
    v_mfma_f32_16x16x32_bf16 v[88:91], v[40:43], v[20:23], v[88:91]
    v_add_u32 v4, s53, v4
    v_add_u32 v5, s53, v5
    v_mfma_f32_16x16x32_bf16 v[84:87], v[36:39], v[20:23], v[84:87]
    v_add_u32 v6, s53, v6
    v_add_u32 v7, s53, v7
    v_mfma_f32_16x16x32_bf16 v[80:83], v[32:35], v[20:23], v[80:83]
    s_sub_u32 s52, s52, 1
    s_cbranch_scc0 cloop_6
    s_waitcnt lgkmcnt(0)
    s_barrier
    v_mfma_f32_16x16x32_bf16 v[64:67], v[48:51], v[24:27], v[64:67]
    v_mfma_f32_16x16x32_bf16 v[68:71], v[52:55], v[24:27], v[68:71]
    v_mfma_f32_16x16x32_bf16 v[72:75], v[56:59], v[24:27], v[72:75]
    v_mfma_f32_16x16x32_bf16 v[76:79], v[60:63], v[24:27], v[76:79]
    v_mfma_f32_16x16x32_bf16 v[92:95], v[60:63], v[28:31], v[92:95]
    v_mfma_f32_16x16x32_bf16 v[88:91], v[56:59], v[28:31], v[88:91]
    v_mfma_f32_16x16x32_bf16 v[84:87], v[52:55], v[28:31], v[84:87]
    v_mfma_f32_16x16x32_bf16 v[80:83], v[48:51], v[28:31], v[80:83]
    s_lshl_b32 s79, s44, 8
    s_lshl_b32 s78, s45, 4
    s_add_u32 s79, s79, s78
    s_lshl_b32 s78, s27, 2
    s_add_u32 s79, s79, s78
    s_add_u32 s79, s79, 32768
    s_add_u32 s36, s24, 8388608
    s_addc_u32 s37, s25, 0
    s_mov_b32 s38, 4194304
    s_mov_b32 s39, 0x20000
    s_add_u32 s40, s24, 29360128
    s_addc_u32 s41, s25, 0
    s_mov_b32 s42, 1048576
    s_mov_b32 s43, 0x20000
    s_lshl_b32 s53, s44, 3
    s_lshl_b32 s54, s27, 1
    s_add_u32 s53, s53, s54
    s_lshl_b32 s54, s53, 15
    s_lshl_b32 s55, s45, 11
    s_add_u32 s54, s54, s55
    s_add_u32 s55, s54, 32768
    s_lshl_b32 s53, s53, 11
    s_lshl_b32 s56, s45, 7
    s_add_u32 s53, s53, s56
    v_lshlrev_b32 v2, 4, v0
    v_lshlrev_b32 v3, 3, v0
    s_waitcnt vmcnt(0)
    v_lshlrev_b32 v112, 16, v200
    v_and_b32 v113, 0xffff0000, v200
    v_lshlrev_b32 v114, 16, v201
    v_and_b32 v115, 0xffff0000, v201
    v_lshlrev_b32 v116, 16, v202
    v_and_b32 v117, 0xffff0000, v202
    v_lshlrev_b32 v118, 16, v203
    v_and_b32 v119, 0xffff0000, v203
    v_lshlrev_b32 v120, 16, v204
    v_and_b32 v121, 0xffff0000, v204
    v_lshlrev_b32 v122, 16, v205
    v_and_b32 v123, 0xffff0000, v205
    v_lshlrev_b32 v124, 16, v206
    v_and_b32 v125, 0xffff0000, v206
    v_lshlrev_b32 v126, 16, v207
    v_and_b32 v127, 0xffff0000, v207
    v_lshlrev_b32 v128, 16, v208
    v_and_b32 v129, 0xffff0000, v208
    v_lshlrev_b32 v130, 16, v209
    v_and_b32 v131, 0xffff0000, v209
    v_lshlrev_b32 v132, 16, v210
    v_and_b32 v133, 0xffff0000, v210
    v_lshlrev_b32 v134, 16, v211
    v_and_b32 v135, 0xffff0000, v211
    v_lshlrev_b32 v136, 16, v212
    v_and_b32 v137, 0xffff0000, v212
    v_lshlrev_b32 v138, 16, v213
    v_and_b32 v139, 0xffff0000, v213
    v_lshlrev_b32 v140, 16, v214
    v_and_b32 v141, 0xffff0000, v214
    v_lshlrev_b32 v142, 16, v215
    v_and_b32 v143, 0xffff0000, v215
    v_pk_add_f32 v[64:65], v[64:65], v[112:113]
    v_pk_add_f32 v[66:67], v[66:67], v[114:115]
    v_pk_add_f32 v[68:69], v[68:69], v[116:117]
    v_pk_add_f32 v[70:71], v[70:71], v[118:119]
    v_pk_add_f32 v[72:73], v[72:73], v[120:121]
    v_pk_add_f32 v[74:75], v[74:75], v[122:123]
    v_pk_add_f32 v[76:77], v[76:77], v[124:125]
    v_pk_add_f32 v[78:79], v[78:79], v[126:127]
    v_pk_add_f32 v[80:81], v[80:81], v[128:129]
    v_pk_add_f32 v[82:83], v[82:83], v[130:131]
    v_pk_add_f32 v[84:85], v[84:85], v[132:133]
    v_pk_add_f32 v[86:87], v[86:87], v[134:135]
    v_pk_add_f32 v[88:89], v[88:89], v[136:137]
    v_pk_add_f32 v[90:91], v[90:91], v[138:139]
    v_pk_add_f32 v[92:93], v[92:93], v[140:141]
    v_pk_add_f32 v[94:95], v[94:95], v[142:143]
    v_cvt_pk_bf16_f32 v20, v64, v65
    v_cvt_pk_bf16_f32 v21, v66, v67
    v_cvt_pk_bf16_f32 v22, v68, v69
    v_cvt_pk_bf16_f32 v23, v70, v71
    buffer_store_dwordx4 v[20:23], v2, s[36:39], s54 offen offset:0 sc1
    v_cvt_pk_bf16_f32 v24, v72, v73
    v_cvt_pk_bf16_f32 v25, v74, v75
    v_cvt_pk_bf16_f32 v26, v76, v77
    v_cvt_pk_bf16_f32 v27, v78, v79
    buffer_store_dwordx4 v[24:27], v2, s[36:39], s54 offen offset:1024 sc1
    v_cvt_pk_bf16_f32 v28, v80, v81
    v_cvt_pk_bf16_f32 v29, v82, v83
    v_cvt_pk_bf16_f32 v30, v84, v85
    v_cvt_pk_bf16_f32 v31, v86, v87
    buffer_store_dwordx4 v[28:31], v2, s[36:39], s55 offen offset:0 sc1
    v_cvt_pk_bf16_f32 v32, v88, v89
    v_cvt_pk_bf16_f32 v33, v90, v91
    v_cvt_pk_bf16_f32 v34, v92, v93
    v_cvt_pk_bf16_f32 v35, v94, v95
    buffer_store_dwordx4 v[32:35], v2, s[36:39], s55 offen offset:1024 sc1
    v_pk_add_f32 v[112:113], v[64:65], v[66:67]
    v_pk_add_f32 v[120:121], v[80:81], v[82:83]
    v_pk_add_f32 v[114:115], v[68:69], v[70:71]
    v_pk_add_f32 v[122:123], v[84:85], v[86:87]
    v_pk_add_f32 v[116:117], v[72:73], v[74:75]
    v_pk_add_f32 v[124:125], v[88:89], v[90:91]
    v_pk_add_f32 v[118:119], v[76:77], v[78:79]
    v_pk_add_f32 v[126:127], v[92:93], v[94:95]
    v_pk_add_f32 v[112:113], v[112:113], v[114:115]
    v_pk_add_f32 v[120:121], v[120:121], v[122:123]
    v_pk_add_f32 v[116:117], v[116:117], v[118:119]
    v_pk_add_f32 v[124:125], v[124:125], v[126:127]
    v_pk_add_f32 v[112:113], v[112:113], v[116:117]
    v_pk_add_f32 v[120:121], v[120:121], v[124:125]
    v_add_f32 v40, v112, v113
    v_add_f32 v48, v120, v121
    v_mov_b32 v41, v40
    v_mov_b32 v49, v48
    s_nop 0
    v_permlane16_swap_b32 v41, v40
    v_permlane16_swap_b32 v49, v48
    v_add_f32 v40, v41, v40
    v_add_f32 v48, v49, v48
    v_mov_b32 v41, v40
    v_mov_b32 v49, v48
    s_nop 0
    v_permlane32_swap_b32 v41, v40
    v_permlane32_swap_b32 v49, v48
    v_add_f32 v40, v41, v40
    v_add_f32 v48, v49, v48
    v_mul_f32 v42, 0x3c800000, v40
    v_mul_f32 v50, 0x3c800000, v48
    v_pk_add_f32 v[64:65], v[64:65], v[42:43] op_sel_hi:[1,0] neg_lo:[0,1] neg_hi:[0,1]
    v_pk_add_f32 v[80:81], v[80:81], v[50:51] op_sel_hi:[1,0] neg_lo:[0,1] neg_hi:[0,1]
    v_pk_add_f32 v[66:67], v[66:67], v[42:43] op_sel_hi:[1,0] neg_lo:[0,1] neg_hi:[0,1]
    v_pk_add_f32 v[82:83], v[82:83], v[50:51] op_sel_hi:[1,0] neg_lo:[0,1] neg_hi:[0,1]
    v_pk_add_f32 v[68:69], v[68:69], v[42:43] op_sel_hi:[1,0] neg_lo:[0,1] neg_hi:[0,1]
    v_pk_add_f32 v[84:85], v[84:85], v[50:51] op_sel_hi:[1,0] neg_lo:[0,1] neg_hi:[0,1]
    v_pk_add_f32 v[70:71], v[70:71], v[42:43] op_sel_hi:[1,0] neg_lo:[0,1] neg_hi:[0,1]
    v_pk_add_f32 v[86:87], v[86:87], v[50:51] op_sel_hi:[1,0] neg_lo:[0,1] neg_hi:[0,1]
    v_pk_add_f32 v[72:73], v[72:73], v[42:43] op_sel_hi:[1,0] neg_lo:[0,1] neg_hi:[0,1]
    v_pk_add_f32 v[88:89], v[88:89], v[50:51] op_sel_hi:[1,0] neg_lo:[0,1] neg_hi:[0,1]
    v_pk_add_f32 v[74:75], v[74:75], v[42:43] op_sel_hi:[1,0] neg_lo:[0,1] neg_hi:[0,1]
    v_pk_add_f32 v[90:91], v[90:91], v[50:51] op_sel_hi:[1,0] neg_lo:[0,1] neg_hi:[0,1]
    v_pk_add_f32 v[76:77], v[76:77], v[42:43] op_sel_hi:[1,0] neg_lo:[0,1] neg_hi:[0,1]
    v_pk_add_f32 v[92:93], v[92:93], v[50:51] op_sel_hi:[1,0] neg_lo:[0,1] neg_hi:[0,1]
    v_pk_add_f32 v[78:79], v[78:79], v[42:43] op_sel_hi:[1,0] neg_lo:[0,1] neg_hi:[0,1]
    v_pk_add_f32 v[94:95], v[94:95], v[50:51] op_sel_hi:[1,0] neg_lo:[0,1] neg_hi:[0,1]
    v_pk_mul_f32 v[112:113], v[64:65], v[64:65]
    v_pk_mul_f32 v[120:121], v[80:81], v[80:81]
    v_pk_mul_f32 v[114:115], v[66:67], v[66:67]
    v_pk_mul_f32 v[122:123], v[82:83], v[82:83]
    v_pk_fma_f32 v[112:113], v[68:69], v[68:69], v[112:113]
    v_pk_fma_f32 v[120:121], v[84:85], v[84:85], v[120:121]
    v_pk_fma_f32 v[114:115], v[70:71], v[70:71], v[114:115]
    v_pk_fma_f32 v[122:123], v[86:87], v[86:87], v[122:123]
    v_pk_fma_f32 v[112:113], v[72:73], v[72:73], v[112:113]
    v_pk_fma_f32 v[120:121], v[88:89], v[88:89], v[120:121]
    v_pk_fma_f32 v[114:115], v[74:75], v[74:75], v[114:115]
    v_pk_fma_f32 v[122:123], v[90:91], v[90:91], v[122:123]
    v_pk_fma_f32 v[112:113], v[76:77], v[76:77], v[112:113]
    v_pk_fma_f32 v[120:121], v[92:93], v[92:93], v[120:121]
    v_pk_fma_f32 v[114:115], v[78:79], v[78:79], v[114:115]
    v_pk_fma_f32 v[122:123], v[94:95], v[94:95], v[122:123]
    v_pk_add_f32 v[112:113], v[112:113], v[114:115]
    v_pk_add_f32 v[120:121], v[120:121], v[122:123]
    v_add_f32 v41, v112, v113
    v_add_f32 v49, v120, v121
    v_mov_b32 v43, v41
    v_mov_b32 v51, v49
    s_nop 0
    v_permlane16_swap_b32 v43, v41
    v_permlane16_swap_b32 v51, v49
    v_add_f32 v41, v43, v41
    v_add_f32 v49, v51, v49
    v_mov_b32 v43, v41
    v_mov_b32 v51, v49
    s_nop 0
    v_permlane32_swap_b32 v43, v41
    v_permlane32_swap_b32 v51, v49
    v_add_f32 v41, v43, v41
    v_add_f32 v49, v51, v49
    s_mov_b32 s77, s53
    s_lshl_b32 s63, s44, 7
    s_lshl_b32 s53, s45, 2
    s_add_u32 s63, s63, s53
    s_add_u32 s63, s63, 12288
    v_mov_b32 v236, 160264
    v_mov_b32 v237, 1
    v_mov_b32 v238, 0
    v_mov_b32 v239, s62
    s_mov_b64 exec, 1
    s_waitcnt vmcnt(0)
    ds_add_rtn_u32 v237, v236, v237
    s_waitcnt lgkmcnt(0)
    v_cmp_ne_u32 vcc, 3, v237
    s_cbranch_vccnz nopub_7
    buffer_store_dword v239, v238, s[96:99], s63 offen sc1
nopub_7:
    s_mov_b64 exec, -1
    s_mov_b32 s53, s77
    s_mov_b64 exec, 0xffff
    buffer_store_dwordx2 v[40:41], v3, s[40:43], s53 offen sc1
    buffer_store_dwordx2 v[48:49], v3, s[40:43], s53 offen offset:2048 sc1
    s_mov_b64 exec, -1
    s_barrier
    s_and_b32 s53, s2, 1
    s_lshl_b32 s53, s53, 3
    s_lshr_b32 s54, s2, 3
    s_and_b32 s55, s54, 7
    s_add_u32 s44, s53, s55
    s_and_b32 s53, s2, 7
    s_lshr_b32 s53, s53, 1
    s_lshl_b32 s53, s53, 2
    s_lshr_b32 s54, s2, 6
    s_add_u32 s45, s53, s54
    s_add_u32 s47, s44, s45
    s_and_b32 s47, s47, 3
    s_lshr_b32 s53, s27, 1
    s_and_b32 s54, s27, 1
    s_lshl_b32 s55, s53, 13
    s_lshl_b32 s56, s54, 12
    s_add_u32 s56, s56, s55
    v_lshlrev_b32 v2, 4, v0
    v_add_u32 v2, s56, v2
    v_xor_b32 v3, 0x1000, v2
    s_lshl_b32 s55, s54, 1
    s_add_u32 s55, s55, 0
    s_and_b32 s55, s55, 3
    v_lshrrev_b32 v10, 2, v0
    v_bfe_u32 v11, v0, 3, 2
    v_xor_b32 v11, s55, v11
    v_lshlrev_b32 v11, 5, v11
    v_lshlrev_b32 v10, 7, v10
    v_add_u32 v4, v10, v11
    v_and_b32 v10, 3, v0
    v_lshlrev_b32 v10, 3, v10
    v_add_u32 v4, v4, v10
    s_mul_i32 s55, s54, 8192
    s_add_u32 s55, s55, 16384
    v_add_u32 v4, s55, v4
    s_lshl_b32 s55, s54, 1
    s_add_u32 s55, s55, 1
    s_and_b32 s55, s55, 3
    v_lshrrev_b32 v10, 2, v0
    v_bfe_u32 v11, v0, 3, 2
    v_xor_b32 v11, s55, v11
    v_lshlrev_b32 v11, 5, v11
    v_lshlrev_b32 v10, 7, v10
    v_add_u32 v5, v10, v11
    v_and_b32 v10, 3, v0
    v_lshlrev_b32 v10, 3, v10
    v_add_u32 v5, v5, v10
    s_mul_i32 s55, s54, 8192
    s_add_u32 s55, s55, 16384
    v_add_u32 v5, s55, v5
    s_lshl_b32 s55, s54, 1
    s_add_u32 s55, s55, 2
    s_and_b32 s55, s55, 3
    v_lshrrev_b32 v10, 2, v0
    v_bfe_u32 v11, v0, 3, 2
    v_xor_b32 v11, s55, v11
    v_lshlrev_b32 v11, 5, v11
    v_lshlrev_b32 v10, 7, v10
    v_add_u32 v6, v10, v11
    v_and_b32 v10, 3, v0
    v_lshlrev_b32 v10, 3, v10
    v_add_u32 v6, v6, v10
    s_mul_i32 s55, s54, 16384
    s_add_u32 s55, s55, 16384
    v_add_u32 v6, s55, v6
    s_lshl_b32 s55, s54, 1
    s_add_u32 s55, s55, 3
    s_and_b32 s55, s55, 3
    v_lshrrev_b32 v10, 2, v0
    v_bfe_u32 v11, v0, 3, 2
    v_xor_b32 v11, s55, v11
    v_lshlrev_b32 v11, 5, v11
    v_lshlrev_b32 v10, 7, v10
    v_add_u32 v7, v10, v11
    v_and_b32 v10, 3, v0
    v_lshlrev_b32 v10, 3, v10
    v_add_u32 v7, v7, v10
    s_mul_i32 s55, s54, 16384
    s_add_u32 s55, s55, 16384
    v_add_u32 v7, s55, v7
    v_lshrrev_b32 v10, 2, v0
    v_bfe_u32 v11, v0, 4, 1
    v_xor_b32 v11, 0, v11
    v_lshlrev_b32 v11, 5, v11
    v_lshlrev_b32 v10, 6, v10
    v_add_u32 v8, v10, v11
    v_and_b32 v10, 3, v0
    v_lshlrev_b32 v10, 3, v10
    v_add_u32 v8, v8, v10
    v_add_u32 v8, 40960, v8
    v_lshrrev_b32 v10, 2, v0
    v_bfe_u32 v11, v0, 4, 1
    v_xor_b32 v11, 1, v11
    v_lshlrev_b32 v11, 5, v11
    v_lshlrev_b32 v10, 6, v10
    v_add_u32 v9, v10, v11
    v_and_b32 v10, 3, v0
    v_lshlrev_b32 v10, 3, v10
    v_add_u32 v9, v9, v10
    v_add_u32 v9, 40960, v9
    s_mov_b32 s51, 0
    s_mov_b32 s52, 14
    s_mov_b32 s54, 0xfffea000
    s_mov_b32 s55, 45056
    s_barrier
    ds_read_b128 v[16:19], v2 offset:0
    ds_read_b128 v[20:23], v2 offset:2048
    ds_read_b128 v[24:27], v3 offset:0
    ds_read_b128 v[28:31], v3 offset:2048
    ds_read_b64_tr_b16 v[48:49], v4 offset:0
    ds_read_b64_tr_b16 v[50:51], v4 offset:2048
    ds_read_b64_tr_b16 v[52:53], v5 offset:0
    ds_read_b64_tr_b16 v[54:55], v5 offset:2048
    ds_read_b64_tr_b16 v[56:57], v6 offset:0
    ds_read_b64_tr_b16 v[58:59], v6 offset:2048
    ds_read_b64_tr_b16 v[60:61], v7 offset:0
    ds_read_b64_tr_b16 v[62:63], v7 offset:2048
    ds_read_b64_tr_b16 v[64:65], v4 offset:8192
    ds_read_b64_tr_b16 v[66:67], v4 offset:10240
    ds_read_b64_tr_b16 v[68:69], v5 offset:8192
    ds_read_b64_tr_b16 v[70:71], v5 offset:10240
    ds_read_b64_tr_b16 v[72:73], v8 offset:0
    ds_read_b64_tr_b16 v[74:75], v8 offset:1024
    ds_read_b64_tr_b16 v[76:77], v9 offset:0
    ds_read_b64_tr_b16 v[78:79], v9 offset:1024
    s_waitcnt lgkmcnt(0)
    v_mfma_f32_16x16x32_bf16 v[112:115], v[48:51], v[16:19], 0
    ds_read_b128 v[32:35], v2 offset:1024
    v_mfma_f32_16x16x32_bf16 v[116:119], v[52:55], v[16:19], 0
    ds_read_b128 v[36:39], v2 offset:3072
    v_mfma_f32_16x16x32_bf16 v[120:123], v[56:59], v[16:19], 0
    ds_read_b128 v[40:43], v3 offset:1024
    v_mfma_f32_16x16x32_bf16 v[124:127], v[60:63], v[16:19], 0
    ds_read_b128 v[44:47], v3 offset:3072
    v_mfma_f32_16x16x32_bf16 v[128:131], v[64:67], v[16:19], 0
    ds_read_b64_tr_b16 v[80:81], v4 offset:4096
    v_mfma_f32_16x16x32_bf16 v[132:135], v[68:71], v[16:19], 0
    ds_read_b64_tr_b16 v[82:83], v4 offset:6144
    v_mfma_f32_16x16x32_bf16 v[136:139], v[48:51], v[20:23], 0
    ds_read_b64_tr_b16 v[84:85], v5 offset:4096
    v_mfma_f32_16x16x32_bf16 v[140:143], v[52:55], v[20:23], 0
    ds_read_b64_tr_b16 v[86:87], v5 offset:6144
    v_mfma_f32_16x16x32_bf16 v[144:147], v[56:59], v[20:23], 0
    ds_read_b64_tr_b16 v[88:89], v6 offset:4096
    v_mfma_f32_16x16x32_bf16 v[148:151], v[60:63], v[20:23], 0
    ds_read_b64_tr_b16 v[90:91], v6 offset:6144
    v_mfma_f32_16x16x32_bf16 v[152:155], v[64:67], v[20:23], 0
    ds_read_b64_tr_b16 v[92:93], v7 offset:4096
    v_mfma_f32_16x16x32_bf16 v[156:159], v[68:71], v[20:23], 0
    ds_read_b64_tr_b16 v[94:95], v7 offset:6144
    v_mfma_f32_16x16x32_bf16 v[160:163], v[48:51], v[24:27], 0
    ds_read_b64_tr_b16 v[96:97], v4 offset:12288
    v_mfma_f32_16x16x32_bf16 v[164:167], v[52:55], v[24:27], 0
    ds_read_b64_tr_b16 v[98:99], v4 offset:14336
    v_mfma_f32_16x16x32_bf16 v[168:171], v[56:59], v[24:27], 0
    ds_read_b64_tr_b16 v[100:101], v5 offset:12288
    v_mfma_f32_16x16x32_bf16 v[172:175], v[60:63], v[24:27], 0
    ds_read_b64_tr_b16 v[102:103], v5 offset:14336
    v_mfma_f32_16x16x32_bf16 v[176:179], v[64:67], v[24:27], 0
    ds_read_b64_tr_b16 v[104:105], v8 offset:2048
    v_mfma_f32_16x16x32_bf16 v[180:183], v[68:71], v[24:27], 0
    ds_read_b64_tr_b16 v[106:107], v8 offset:3072
    v_mfma_f32_16x16x32_bf16 v[184:187], v[48:51], v[28:31], 0
    ds_read_b64_tr_b16 v[108:109], v9 offset:2048
    v_mfma_f32_16x16x32_bf16 v[188:191], v[52:55], v[28:31], 0
    ds_read_b64_tr_b16 v[110:111], v9 offset:3072
    v_mfma_f32_16x16x32_bf16 v[192:195], v[56:59], v[28:31], 0
    s_add_u32 s51, s51, 45056
    s_cmp_ge_u32 s51, 135168
    v_mfma_f32_16x16x32_bf16 v[196:199], v[60:63], v[28:31], 0
    s_cselect_b32 s51, 0, s51
    s_cselect_b32 s53, s54, s55
    v_mfma_f32_16x16x32_bf16 v[200:203], v[64:67], v[28:31], 0
    v_add_u32 v2, s53, v2
    v_add_u32 v3, s53, v3
    v_mfma_f32_16x16x32_bf16 v[204:207], v[68:71], v[28:31], 0
    v_add_u32 v4, s53, v4
    v_mfma_f32_16x16x32_bf16 v[208:211], v[72:75], v[16:19], 0
    v_add_u32 v5, s53, v5
    v_add_u32 v6, s53, v6
    v_mfma_f32_16x16x32_bf16 v[212:215], v[76:79], v[16:19], 0
    v_add_u32 v7, s53, v7
    v_add_u32 v8, s53, v8
    v_mfma_f32_16x16x32_bf16 v[216:219], v[72:75], v[20:23], 0
    v_add_u32 v9, s53, v9
    v_mfma_f32_16x16x32_bf16 v[220:223], v[76:79], v[20:23], 0
    v_mov_b32 v240, 0
    v_mov_b32 v241, s62
    s_waitcnt vmcnt(0)
    s_mov_b64 exec, 1
    buffer_store_dword v241, v240, s[96:99], s79 offen sc1
    s_mov_b64 exec, -1
cloop_8:
    s_waitcnt lgkmcnt(0)
    v_mfma_f32_16x16x32_bf16 v[112:115], v[80:83], v[32:35], v[112:115]
    v_mfma_f32_16x16x32_bf16 v[116:119], v[84:87], v[32:35], v[116:119]
    v_mfma_f32_16x16x32_bf16 v[120:123], v[88:91], v[32:35], v[120:123]
    v_mfma_f32_16x16x32_bf16 v[124:127], v[92:95], v[32:35], v[124:127]
    s_barrier
    v_mfma_f32_16x16x32_bf16 v[128:131], v[96:99], v[32:35], v[128:131]
    ds_read_b128 v[16:19], v2 offset:0
    v_mfma_f32_16x16x32_bf16 v[132:135], v[100:103], v[32:35], v[132:135]
    ds_read_b128 v[20:23], v2 offset:2048
    v_mfma_f32_16x16x32_bf16 v[136:139], v[80:83], v[36:39], v[136:139]
    ds_read_b128 v[24:27], v3 offset:0
    v_mfma_f32_16x16x32_bf16 v[140:143], v[84:87], v[36:39], v[140:143]
    ds_read_b128 v[28:31], v3 offset:2048
    v_mfma_f32_16x16x32_bf16 v[144:147], v[88:91], v[36:39], v[144:147]
    ds_read_b64_tr_b16 v[48:49], v4 offset:0
    v_mfma_f32_16x16x32_bf16 v[148:151], v[92:95], v[36:39], v[148:151]
    ds_read_b64_tr_b16 v[50:51], v4 offset:2048
    v_mfma_f32_16x16x32_bf16 v[152:155], v[96:99], v[36:39], v[152:155]
    ds_read_b64_tr_b16 v[52:53], v5 offset:0
    v_mfma_f32_16x16x32_bf16 v[156:159], v[100:103], v[36:39], v[156:159]
    ds_read_b64_tr_b16 v[54:55], v5 offset:2048
    v_mfma_f32_16x16x32_bf16 v[160:163], v[80:83], v[40:43], v[160:163]
    ds_read_b64_tr_b16 v[56:57], v6 offset:0
    v_mfma_f32_16x16x32_bf16 v[164:167], v[84:87], v[40:43], v[164:167]
    ds_read_b64_tr_b16 v[58:59], v6 offset:2048
    v_mfma_f32_16x16x32_bf16 v[168:171], v[88:91], v[40:43], v[168:171]
    ds_read_b64_tr_b16 v[60:61], v7 offset:0
    v_mfma_f32_16x16x32_bf16 v[172:175], v[92:95], v[40:43], v[172:175]
    ds_read_b64_tr_b16 v[62:63], v7 offset:2048
    v_mfma_f32_16x16x32_bf16 v[176:179], v[96:99], v[40:43], v[176:179]
    ds_read_b64_tr_b16 v[64:65], v4 offset:8192
    v_mfma_f32_16x16x32_bf16 v[180:183], v[100:103], v[40:43], v[180:183]
    ds_read_b64_tr_b16 v[66:67], v4 offset:10240
    v_mfma_f32_16x16x32_bf16 v[184:187], v[80:83], v[44:47], v[184:187]
    ds_read_b64_tr_b16 v[68:69], v5 offset:8192
    v_mfma_f32_16x16x32_bf16 v[188:191], v[84:87], v[44:47], v[188:191]
    ds_read_b64_tr_b16 v[70:71], v5 offset:10240
    v_mfma_f32_16x16x32_bf16 v[192:195], v[88:91], v[44:47], v[192:195]
    ds_read_b64_tr_b16 v[72:73], v8 offset:0
    v_mfma_f32_16x16x32_bf16 v[196:199], v[92:95], v[44:47], v[196:199]
    ds_read_b64_tr_b16 v[74:75], v8 offset:1024
    v_mfma_f32_16x16x32_bf16 v[200:203], v[96:99], v[44:47], v[200:203]
    ds_read_b64_tr_b16 v[76:77], v9 offset:0
    v_mfma_f32_16x16x32_bf16 v[204:207], v[100:103], v[44:47], v[204:207]
    ds_read_b64_tr_b16 v[78:79], v9 offset:1024
    v_mfma_f32_16x16x32_bf16 v[208:211], v[104:107], v[32:35], v[208:211]
    v_mfma_f32_16x16x32_bf16 v[212:215], v[108:111], v[32:35], v[212:215]
    v_mfma_f32_16x16x32_bf16 v[216:219], v[104:107], v[36:39], v[216:219]
    v_mfma_f32_16x16x32_bf16 v[220:223], v[108:111], v[36:39], v[220:223]
    s_waitcnt lgkmcnt(0)
    v_mfma_f32_16x16x32_bf16 v[112:115], v[48:51], v[16:19], v[112:115]
    ds_read_b128 v[32:35], v2 offset:1024
    v_mfma_f32_16x16x32_bf16 v[116:119], v[52:55], v[16:19], v[116:119]
    ds_read_b128 v[36:39], v2 offset:3072
    v_mfma_f32_16x16x32_bf16 v[120:123], v[56:59], v[16:19], v[120:123]
    ds_read_b128 v[40:43], v3 offset:1024
    v_mfma_f32_16x16x32_bf16 v[124:127], v[60:63], v[16:19], v[124:127]
    ds_read_b128 v[44:47], v3 offset:3072
    v_mfma_f32_16x16x32_bf16 v[128:131], v[64:67], v[16:19], v[128:131]
    ds_read_b64_tr_b16 v[80:81], v4 offset:4096
    v_mfma_f32_16x16x32_bf16 v[132:135], v[68:71], v[16:19], v[132:135]
    ds_read_b64_tr_b16 v[82:83], v4 offset:6144
    v_mfma_f32_16x16x32_bf16 v[136:139], v[48:51], v[20:23], v[136:139]
    ds_read_b64_tr_b16 v[84:85], v5 offset:4096
    v_mfma_f32_16x16x32_bf16 v[140:143], v[52:55], v[20:23], v[140:143]
    ds_read_b64_tr_b16 v[86:87], v5 offset:6144
    v_mfma_f32_16x16x32_bf16 v[144:147], v[56:59], v[20:23], v[144:147]
    ds_read_b64_tr_b16 v[88:89], v6 offset:4096
    v_mfma_f32_16x16x32_bf16 v[148:151], v[60:63], v[20:23], v[148:151]
    ds_read_b64_tr_b16 v[90:91], v6 offset:6144
    v_mfma_f32_16x16x32_bf16 v[152:155], v[64:67], v[20:23], v[152:155]
    ds_read_b64_tr_b16 v[92:93], v7 offset:4096
    v_mfma_f32_16x16x32_bf16 v[156:159], v[68:71], v[20:23], v[156:159]
    ds_read_b64_tr_b16 v[94:95], v7 offset:6144
    v_mfma_f32_16x16x32_bf16 v[160:163], v[48:51], v[24:27], v[160:163]
    ds_read_b64_tr_b16 v[96:97], v4 offset:12288
    v_mfma_f32_16x16x32_bf16 v[164:167], v[52:55], v[24:27], v[164:167]
    ds_read_b64_tr_b16 v[98:99], v4 offset:14336
    v_mfma_f32_16x16x32_bf16 v[168:171], v[56:59], v[24:27], v[168:171]
    ds_read_b64_tr_b16 v[100:101], v5 offset:12288
    v_mfma_f32_16x16x32_bf16 v[172:175], v[60:63], v[24:27], v[172:175]
    ds_read_b64_tr_b16 v[102:103], v5 offset:14336
    v_mfma_f32_16x16x32_bf16 v[176:179], v[64:67], v[24:27], v[176:179]
    ds_read_b64_tr_b16 v[104:105], v8 offset:2048
    v_mfma_f32_16x16x32_bf16 v[180:183], v[68:71], v[24:27], v[180:183]
    ds_read_b64_tr_b16 v[106:107], v8 offset:3072
    v_mfma_f32_16x16x32_bf16 v[184:187], v[48:51], v[28:31], v[184:187]
    ds_read_b64_tr_b16 v[108:109], v9 offset:2048
    v_mfma_f32_16x16x32_bf16 v[188:191], v[52:55], v[28:31], v[188:191]
    ds_read_b64_tr_b16 v[110:111], v9 offset:3072
    v_mfma_f32_16x16x32_bf16 v[192:195], v[56:59], v[28:31], v[192:195]
    s_add_u32 s51, s51, 45056
    s_cmp_ge_u32 s51, 135168
    v_mfma_f32_16x16x32_bf16 v[196:199], v[60:63], v[28:31], v[196:199]
    s_cselect_b32 s51, 0, s51
    s_cselect_b32 s53, s54, s55
    v_mfma_f32_16x16x32_bf16 v[200:203], v[64:67], v[28:31], v[200:203]
    v_add_u32 v2, s53, v2
    v_add_u32 v3, s53, v3
    v_mfma_f32_16x16x32_bf16 v[204:207], v[68:71], v[28:31], v[204:207]
    v_add_u32 v4, s53, v4
    v_mfma_f32_16x16x32_bf16 v[208:211], v[72:75], v[16:19], v[208:211]
    v_add_u32 v5, s53, v5
    v_add_u32 v6, s53, v6
    v_mfma_f32_16x16x32_bf16 v[212:215], v[76:79], v[16:19], v[212:215]
    v_add_u32 v7, s53, v7
    v_add_u32 v8, s53, v8
    v_mfma_f32_16x16x32_bf16 v[216:219], v[72:75], v[20:23], v[216:219]
    v_add_u32 v9, s53, v9
    v_mfma_f32_16x16x32_bf16 v[220:223], v[76:79], v[20:23], v[220:223]
    s_sub_u32 s52, s52, 1
    s_cbranch_scc0 cloop_8
    s_waitcnt lgkmcnt(0)
    v_mfma_f32_16x16x32_bf16 v[112:115], v[80:83], v[32:35], v[112:115]
    v_mfma_f32_16x16x32_bf16 v[116:119], v[84:87], v[32:35], v[116:119]
    v_mfma_f32_16x16x32_bf16 v[120:123], v[88:91], v[32:35], v[120:123]
    v_mfma_f32_16x16x32_bf16 v[124:127], v[92:95], v[32:35], v[124:127]
    s_barrier
    v_mfma_f32_16x16x32_bf16 v[128:131], v[96:99], v[32:35], v[128:131]
    v_mfma_f32_16x16x32_bf16 v[132:135], v[100:103], v[32:35], v[132:135]
    v_mfma_f32_16x16x32_bf16 v[136:139], v[80:83], v[36:39], v[136:139]
    v_mfma_f32_16x16x32_bf16 v[140:143], v[84:87], v[36:39], v[140:143]
    v_mfma_f32_16x16x32_bf16 v[144:147], v[88:91], v[36:39], v[144:147]
    v_mfma_f32_16x16x32_bf16 v[148:151], v[92:95], v[36:39], v[148:151]
    v_mfma_f32_16x16x32_bf16 v[152:155], v[96:99], v[36:39], v[152:155]
    v_mfma_f32_16x16x32_bf16 v[156:159], v[100:103], v[36:39], v[156:159]
    v_mfma_f32_16x16x32_bf16 v[160:163], v[80:83], v[40:43], v[160:163]
    v_mfma_f32_16x16x32_bf16 v[164:167], v[84:87], v[40:43], v[164:167]
    v_mfma_f32_16x16x32_bf16 v[168:171], v[88:91], v[40:43], v[168:171]
    v_mfma_f32_16x16x32_bf16 v[172:175], v[92:95], v[40:43], v[172:175]
    v_mfma_f32_16x16x32_bf16 v[176:179], v[96:99], v[40:43], v[176:179]
    v_mfma_f32_16x16x32_bf16 v[180:183], v[100:103], v[40:43], v[180:183]
    v_mfma_f32_16x16x32_bf16 v[184:187], v[80:83], v[44:47], v[184:187]
    v_mfma_f32_16x16x32_bf16 v[188:191], v[84:87], v[44:47], v[188:191]
    v_mfma_f32_16x16x32_bf16 v[192:195], v[88:91], v[44:47], v[192:195]
    v_mfma_f32_16x16x32_bf16 v[196:199], v[92:95], v[44:47], v[196:199]
    v_mfma_f32_16x16x32_bf16 v[200:203], v[96:99], v[44:47], v[200:203]
    v_mfma_f32_16x16x32_bf16 v[204:207], v[100:103], v[44:47], v[204:207]
    v_mfma_f32_16x16x32_bf16 v[208:211], v[104:107], v[32:35], v[208:211]
    v_mfma_f32_16x16x32_bf16 v[212:215], v[108:111], v[32:35], v[212:215]
    v_mfma_f32_16x16x32_bf16 v[216:219], v[104:107], v[36:39], v[216:219]
    v_mfma_f32_16x16x32_bf16 v[220:223], v[108:111], v[36:39], v[220:223]
    s_barrier
    s_add_u32 s36, s24, 12582912
    s_addc_u32 s37, s25, 0
    s_mov_b32 s38, 16777216
    s_mov_b32 s39, 0x20000
    s_lshr_b32 s53, s27, 1
    s_and_b32 s54, s27, 1
    s_lshl_b32 s55, s53, 9
    s_lshl_b32 s56, s54, 8
    s_add_u32 s55, s55, s56
    s_add_u32 s55, s55, 135168
    v_and_b32 v2, 15, v0
    v_lshlrev_b32 v2, 3, v2
    v_add_u32 v2, s55, v2
    v_xor_b32 v3, 0x100, v2
    ds_read_b64 v[8:9], v2 offset:0
    ds_read_b64 v[10:11], v2 offset:128
    ds_read_b64 v[12:13], v3 offset:0
    ds_read_b64 v[14:15], v3 offset:128
    s_mul_i32 s55, s54, 384
    s_add_u32 s55, s55, 136192
    v_and_b32 v5, 0x30, v0
    v_add_u32 v4, s55, v5
    v_add_u32 v5, 136960, v5
    ds_read_b128 v[16:19], v4 offset:0
    ds_read_b128 v[48:51], v4 offset:896
    ds_read_b128 v[20:23], v4 offset:64
    ds_read_b128 v[52:55], v4 offset:960
    ds_read_b128 v[24:27], v4 offset:128
    ds_read_b128 v[56:59], v4 offset:1024
    ds_read_b128 v[28:31], v4 offset:192
    ds_read_b128 v[60:63], v4 offset:1088
    ds_read_b128 v[32:35], v4 offset:256
    ds_read_b128 v[64:67], v4 offset:1152
    ds_read_b128 v[36:39], v4 offset:320
    ds_read_b128 v[68:71], v4 offset:1216
    ds_read_b128 v[40:43], v5 offset:0
    ds_read_b128 v[72:75], v5 offset:896
    ds_read_b128 v[44:47], v5 offset:64
    ds_read_b128 v[76:79], v5 offset:960
    s_lshl_b32 s55, s44, 3
    s_lshl_b32 s56, s53, 2
    s_add_u32 s55, s55, s56
    s_lshl_b32 s56, s54, 1
    s_xor_b32 s84, s56, 0
    s_add_u32 s84, s84, s55
    s_mul_i32 s84, s84, 114688
    s_xor_b32 s85, s56, 1
    s_add_u32 s85, s85, s55
    s_mul_i32 s85, s85, 114688
    s_xor_b32 s86, s56, 2
    s_add_u32 s86, s86, s55
    s_mul_i32 s86, s86, 114688
    s_xor_b32 s87, s56, 3
    s_add_u32 s87, s87, s55
    s_mul_i32 s87, s87, 114688
    s_mul_i32 s55, s45, 7
    s_and_b32 s56, s45, 1
    s_mul_i32 s88, s54, 3
    s_add_u32 s88, s88, s55
    s_add_u32 s88, s88, s56
    s_lshl_b32 s88, s88, 10
    s_cmp_eq_u32 s56, 0
    s_cselect_b32 s89, 6, 0
    s_add_u32 s89, s89, s55
    s_lshl_b32 s89, s89, 10
    v_lshlrev_b32 v6, 4, v0
    v_add_u32 v7, s89, v6
    v_add_u32 v6, s88, v6
    v_mov_b32 v224, 0xbdd2d3e8
    v_mov_b32 v225, 0xc0135761
    v_mov_b32 v226, 1.0
    v_mov_b32 v227, 1.0
    s_waitcnt lgkmcnt(0)
    v_pk_fma_f32 v[80:81], v[8:9], v[16:17], v[48:49] op_sel:[1,0,0] op_sel_hi:[1,1,1] neg_lo:[1,0,0] neg_hi:[1,0,0]
    v_pk_fma_f32 v[82:83], v[8:9], v[18:19], v[50:51] op_sel:[1,0,0] op_sel_hi:[1,1,1] neg_lo:[1,0,0] neg_hi:[1,0,0]
    v_pk_fma_f32 v[84:85], v[8:9], v[20:21], v[52:53] op_sel:[1,0,0] op_sel_hi:[1,1,1] neg_lo:[1,0,0] neg_hi:[1,0,0]
    v_pk_fma_f32 v[86:87], v[8:9], v[22:23], v[54:55] op_sel:[1,0,0] op_sel_hi:[1,1,1] neg_lo:[1,0,0] neg_hi:[1,0,0]
    v_pk_fma_f32 v[112:113], v[8:9], v[112:113], v[80:81] op_sel_hi:[0,1,1]
    v_pk_fma_f32 v[114:115], v[8:9], v[114:115], v[82:83] op_sel_hi:[0,1,1]
    v_pk_fma_f32 v[116:117], v[8:9], v[116:117], v[84:85] op_sel_hi:[0,1,1]
    v_pk_fma_f32 v[118:119], v[8:9], v[118:119], v[86:87] op_sel_hi:[0,1,1]
    v_pk_mul_f32 v[80:81], v[112:113], v[112:113]
    v_pk_mul_f32 v[82:83], v[114:115], v[114:115]
    v_pk_mul_f32 v[84:85], v[116:117], v[116:117]
    v_pk_mul_f32 v[86:87], v[118:119], v[118:119]
    v_pk_fma_f32 v[80:81], v[80:81], v[224:225], v[224:225] op_sel:[0,0,1] op_sel_hi:[1,0,1]
    v_pk_fma_f32 v[82:83], v[82:83], v[224:225], v[224:225] op_sel:[0,0,1] op_sel_hi:[1,0,1]
    v_pk_fma_f32 v[84:85], v[84:85], v[224:225], v[224:225] op_sel:[0,0,1] op_sel_hi:[1,0,1]
    v_pk_fma_f32 v[86:87], v[86:87], v[224:225], v[224:225] op_sel:[0,0,1] op_sel_hi:[1,0,1]
    v_pk_mul_f32 v[80:81], v[80:81], v[112:113]
    v_pk_mul_f32 v[82:83], v[82:83], v[114:115]
    v_pk_mul_f32 v[84:85], v[84:85], v[116:117]
    v_pk_mul_f32 v[86:87], v[86:87], v[118:119]
    v_exp_f32 v80, v80
    v_exp_f32 v81, v81
    v_exp_f32 v82, v82
    v_exp_f32 v83, v83
    v_exp_f32 v84, v84
    v_exp_f32 v85, v85
    v_exp_f32 v86, v86
    v_exp_f32 v87, v87
    v_pk_add_f32 v[80:81], v[80:81], v[226:227]
    v_pk_add_f32 v[82:83], v[82:83], v[226:227]
    v_pk_add_f32 v[84:85], v[84:85], v[226:227]
    v_pk_add_f32 v[86:87], v[86:87], v[226:227]
    v_rcp_f32 v80, v80
    v_rcp_f32 v81, v81
    v_rcp_f32 v82, v82
    v_rcp_f32 v83, v83
    v_rcp_f32 v84, v84
    v_rcp_f32 v85, v85
    v_rcp_f32 v86, v86
    v_rcp_f32 v87, v87
    v_pk_mul_f32 v[112:113], v[112:113], v[80:81]
    v_pk_mul_f32 v[114:115], v[114:115], v[82:83]
    v_pk_mul_f32 v[116:117], v[116:117], v[84:85]
    v_pk_mul_f32 v[118:119], v[118:119], v[86:87]
    v_cvt_pk_bf16_f32 v88, v112, v113
    v_cvt_pk_bf16_f32 v89, v114, v115
    v_cvt_pk_bf16_f32 v90, v116, v117
    v_cvt_pk_bf16_f32 v91, v118, v119
    buffer_store_dwordx4 v[88:91], v6, s[36:39], s84 offen offset:0 sc1
    v_pk_fma_f32 v[96:97], v[10:11], v[16:17], v[48:49] op_sel:[1,0,0] op_sel_hi:[1,1,1] neg_lo:[1,0,0] neg_hi:[1,0,0]
    v_pk_fma_f32 v[98:99], v[10:11], v[18:19], v[50:51] op_sel:[1,0,0] op_sel_hi:[1,1,1] neg_lo:[1,0,0] neg_hi:[1,0,0]
    v_pk_fma_f32 v[100:101], v[10:11], v[20:21], v[52:53] op_sel:[1,0,0] op_sel_hi:[1,1,1] neg_lo:[1,0,0] neg_hi:[1,0,0]
    v_pk_fma_f32 v[102:103], v[10:11], v[22:23], v[54:55] op_sel:[1,0,0] op_sel_hi:[1,1,1] neg_lo:[1,0,0] neg_hi:[1,0,0]
    v_pk_fma_f32 v[136:137], v[10:11], v[136:137], v[96:97] op_sel_hi:[0,1,1]
    v_pk_fma_f32 v[138:139], v[10:11], v[138:139], v[98:99] op_sel_hi:[0,1,1]
    v_pk_fma_f32 v[140:141], v[10:11], v[140:141], v[100:101] op_sel_hi:[0,1,1]
    v_pk_fma_f32 v[142:143], v[10:11], v[142:143], v[102:103] op_sel_hi:[0,1,1]
    v_pk_mul_f32 v[96:97], v[136:137], v[136:137]
    v_pk_mul_f32 v[98:99], v[138:139], v[138:139]
    v_pk_mul_f32 v[100:101], v[140:141], v[140:141]
    v_pk_mul_f32 v[102:103], v[142:143], v[142:143]
    v_pk_fma_f32 v[96:97], v[96:97], v[224:225], v[224:225] op_sel:[0,0,1] op_sel_hi:[1,0,1]
    v_pk_fma_f32 v[98:99], v[98:99], v[224:225], v[224:225] op_sel:[0,0,1] op_sel_hi:[1,0,1]
    v_pk_fma_f32 v[100:101], v[100:101], v[224:225], v[224:225] op_sel:[0,0,1] op_sel_hi:[1,0,1]
    v_pk_fma_f32 v[102:103], v[102:103], v[224:225], v[224:225] op_sel:[0,0,1] op_sel_hi:[1,0,1]
    v_pk_mul_f32 v[96:97], v[96:97], v[136:137]
    v_pk_mul_f32 v[98:99], v[98:99], v[138:139]
    v_pk_mul_f32 v[100:101], v[100:101], v[140:141]
    v_pk_mul_f32 v[102:103], v[102:103], v[142:143]
    v_exp_f32 v96, v96
    v_exp_f32 v97, v97
    v_exp_f32 v98, v98
    v_exp_f32 v99, v99
    v_exp_f32 v100, v100
    v_exp_f32 v101, v101
    v_exp_f32 v102, v102
    v_exp_f32 v103, v103
    v_pk_add_f32 v[96:97], v[96:97], v[226:227]
    v_pk_add_f32 v[98:99], v[98:99], v[226:227]
    v_pk_add_f32 v[100:101], v[100:101], v[226:227]
    v_pk_add_f32 v[102:103], v[102:103], v[226:227]
    v_rcp_f32 v96, v96
    v_rcp_f32 v97, v97
    v_rcp_f32 v98, v98
    v_rcp_f32 v99, v99
    v_rcp_f32 v100, v100
    v_rcp_f32 v101, v101
    v_rcp_f32 v102, v102
    v_rcp_f32 v103, v103
    v_pk_mul_f32 v[136:137], v[136:137], v[96:97]
    v_pk_mul_f32 v[138:139], v[138:139], v[98:99]
    v_pk_mul_f32 v[140:141], v[140:141], v[100:101]
    v_pk_mul_f32 v[142:143], v[142:143], v[102:103]
    v_cvt_pk_bf16_f32 v104, v136, v137
    v_cvt_pk_bf16_f32 v105, v138, v139
    v_cvt_pk_bf16_f32 v106, v140, v141
    v_cvt_pk_bf16_f32 v107, v142, v143
    buffer_store_dwordx4 v[104:107], v6, s[36:39], s85 offen offset:0 sc1
    v_pk_fma_f32 v[80:81], v[12:13], v[16:17], v[48:49] op_sel:[1,0,0] op_sel_hi:[1,1,1] neg_lo:[1,0,0] neg_hi:[1,0,0]
    v_pk_fma_f32 v[82:83], v[12:13], v[18:19], v[50:51] op_sel:[1,0,0] op_sel_hi:[1,1,1] neg_lo:[1,0,0] neg_hi:[1,0,0]
    v_pk_fma_f32 v[84:85], v[12:13], v[20:21], v[52:53] op_sel:[1,0,0] op_sel_hi:[1,1,1] neg_lo:[1,0,0] neg_hi:[1,0,0]
    v_pk_fma_f32 v[86:87], v[12:13], v[22:23], v[54:55] op_sel:[1,0,0] op_sel_hi:[1,1,1] neg_lo:[1,0,0] neg_hi:[1,0,0]
    v_pk_fma_f32 v[160:161], v[12:13], v[160:161], v[80:81] op_sel_hi:[0,1,1]
    v_pk_fma_f32 v[162:163], v[12:13], v[162:163], v[82:83] op_sel_hi:[0,1,1]
    v_pk_fma_f32 v[164:165], v[12:13], v[164:165], v[84:85] op_sel_hi:[0,1,1]
    v_pk_fma_f32 v[166:167], v[12:13], v[166:167], v[86:87] op_sel_hi:[0,1,1]
    v_pk_mul_f32 v[80:81], v[160:161], v[160:161]
    v_pk_mul_f32 v[82:83], v[162:163], v[162:163]
    v_pk_mul_f32 v[84:85], v[164:165], v[164:165]
    v_pk_mul_f32 v[86:87], v[166:167], v[166:167]
    v_pk_fma_f32 v[80:81], v[80:81], v[224:225], v[224:225] op_sel:[0,0,1] op_sel_hi:[1,0,1]
    v_pk_fma_f32 v[82:83], v[82:83], v[224:225], v[224:225] op_sel:[0,0,1] op_sel_hi:[1,0,1]
    v_pk_fma_f32 v[84:85], v[84:85], v[224:225], v[224:225] op_sel:[0,0,1] op_sel_hi:[1,0,1]
    v_pk_fma_f32 v[86:87], v[86:87], v[224:225], v[224:225] op_sel:[0,0,1] op_sel_hi:[1,0,1]
    v_pk_mul_f32 v[80:81], v[80:81], v[160:161]
    v_pk_mul_f32 v[82:83], v[82:83], v[162:163]
    v_pk_mul_f32 v[84:85], v[84:85], v[164:165]
    v_pk_mul_f32 v[86:87], v[86:87], v[166:167]
    v_exp_f32 v80, v80
    v_exp_f32 v81, v81
    v_exp_f32 v82, v82
    v_exp_f32 v83, v83
    v_exp_f32 v84, v84
    v_exp_f32 v85, v85
    v_exp_f32 v86, v86
    v_exp_f32 v87, v87
    v_pk_add_f32 v[80:81], v[80:81], v[226:227]
    v_pk_add_f32 v[82:83], v[82:83], v[226:227]
    v_pk_add_f32 v[84:85], v[84:85], v[226:227]
    v_pk_add_f32 v[86:87], v[86:87], v[226:227]
    v_rcp_f32 v80, v80
    v_rcp_f32 v81, v81
    v_rcp_f32 v82, v82
    v_rcp_f32 v83, v83
    v_rcp_f32 v84, v84
    v_rcp_f32 v85, v85
    v_rcp_f32 v86, v86
    v_rcp_f32 v87, v87
    v_pk_mul_f32 v[160:161], v[160:161], v[80:81]
    v_pk_mul_f32 v[162:163], v[162:163], v[82:83]
    v_pk_mul_f32 v[164:165], v[164:165], v[84:85]
    v_pk_mul_f32 v[166:167], v[166:167], v[86:87]
    v_cvt_pk_bf16_f32 v88, v160, v161
    v_cvt_pk_bf16_f32 v89, v162, v163
    v_cvt_pk_bf16_f32 v90, v164, v165
    v_cvt_pk_bf16_f32 v91, v166, v167
    buffer_store_dwordx4 v[88:91], v6, s[36:39], s86 offen offset:0 sc1
    v_pk_fma_f32 v[96:97], v[14:15], v[16:17], v[48:49] op_sel:[1,0,0] op_sel_hi:[1,1,1] neg_lo:[1,0,0] neg_hi:[1,0,0]
    v_pk_fma_f32 v[98:99], v[14:15], v[18:19], v[50:51] op_sel:[1,0,0] op_sel_hi:[1,1,1] neg_lo:[1,0,0] neg_hi:[1,0,0]
    v_pk_fma_f32 v[100:101], v[14:15], v[20:21], v[52:53] op_sel:[1,0,0] op_sel_hi:[1,1,1] neg_lo:[1,0,0] neg_hi:[1,0,0]
    v_pk_fma_f32 v[102:103], v[14:15], v[22:23], v[54:55] op_sel:[1,0,0] op_sel_hi:[1,1,1] neg_lo:[1,0,0] neg_hi:[1,0,0]
    v_pk_fma_f32 v[184:185], v[14:15], v[184:185], v[96:97] op_sel_hi:[0,1,1]
    v_pk_fma_f32 v[186:187], v[14:15], v[186:187], v[98:99] op_sel_hi:[0,1,1]
    v_pk_fma_f32 v[188:189], v[14:15], v[188:189], v[100:101] op_sel_hi:[0,1,1]
    v_pk_fma_f32 v[190:191], v[14:15], v[190:191], v[102:103] op_sel_hi:[0,1,1]
    v_pk_mul_f32 v[96:97], v[184:185], v[184:185]
    v_pk_mul_f32 v[98:99], v[186:187], v[186:187]
    v_pk_mul_f32 v[100:101], v[188:189], v[188:189]
    v_pk_mul_f32 v[102:103], v[190:191], v[190:191]
    v_pk_fma_f32 v[96:97], v[96:97], v[224:225], v[224:225] op_sel:[0,0,1] op_sel_hi:[1,0,1]
    v_pk_fma_f32 v[98:99], v[98:99], v[224:225], v[224:225] op_sel:[0,0,1] op_sel_hi:[1,0,1]
    v_pk_fma_f32 v[100:101], v[100:101], v[224:225], v[224:225] op_sel:[0,0,1] op_sel_hi:[1,0,1]
    v_pk_fma_f32 v[102:103], v[102:103], v[224:225], v[224:225] op_sel:[0,0,1] op_sel_hi:[1,0,1]
    v_pk_mul_f32 v[96:97], v[96:97], v[184:185]
    v_pk_mul_f32 v[98:99], v[98:99], v[186:187]
    v_pk_mul_f32 v[100:101], v[100:101], v[188:189]
    v_pk_mul_f32 v[102:103], v[102:103], v[190:191]
    v_exp_f32 v96, v96
    v_exp_f32 v97, v97
    v_exp_f32 v98, v98
    v_exp_f32 v99, v99
    v_exp_f32 v100, v100
    v_exp_f32 v101, v101
    v_exp_f32 v102, v102
    v_exp_f32 v103, v103
    v_pk_add_f32 v[96:97], v[96:97], v[226:227]
    v_pk_add_f32 v[98:99], v[98:99], v[226:227]
    v_pk_add_f32 v[100:101], v[100:101], v[226:227]
    v_pk_add_f32 v[102:103], v[102:103], v[226:227]
    v_rcp_f32 v96, v96
    v_rcp_f32 v97, v97
    v_rcp_f32 v98, v98
    v_rcp_f32 v99, v99
    v_rcp_f32 v100, v100
    v_rcp_f32 v101, v101
    v_rcp_f32 v102, v102
    v_rcp_f32 v103, v103
    v_pk_mul_f32 v[184:185], v[184:185], v[96:97]
    v_pk_mul_f32 v[186:187], v[186:187], v[98:99]
    v_pk_mul_f32 v[188:189], v[188:189], v[100:101]
    v_pk_mul_f32 v[190:191], v[190:191], v[102:103]
    v_cvt_pk_bf16_f32 v104, v184, v185
    v_cvt_pk_bf16_f32 v105, v186, v187
    v_cvt_pk_bf16_f32 v106, v188, v189
    v_cvt_pk_bf16_f32 v107, v190, v191
    buffer_store_dwordx4 v[104:107], v6, s[36:39], s87 offen offset:0 sc1
    v_pk_fma_f32 v[80:81], v[8:9], v[24:25], v[56:57] op_sel:[1,0,0] op_sel_hi:[1,1,1] neg_lo:[1,0,0] neg_hi:[1,0,0]
    v_pk_fma_f32 v[82:83], v[8:9], v[26:27], v[58:59] op_sel:[1,0,0] op_sel_hi:[1,1,1] neg_lo:[1,0,0] neg_hi:[1,0,0]
    v_pk_fma_f32 v[84:85], v[8:9], v[28:29], v[60:61] op_sel:[1,0,0] op_sel_hi:[1,1,1] neg_lo:[1,0,0] neg_hi:[1,0,0]
    v_pk_fma_f32 v[86:87], v[8:9], v[30:31], v[62:63] op_sel:[1,0,0] op_sel_hi:[1,1,1] neg_lo:[1,0,0] neg_hi:[1,0,0]
    v_pk_fma_f32 v[120:121], v[8:9], v[120:121], v[80:81] op_sel_hi:[0,1,1]
    v_pk_fma_f32 v[122:123], v[8:9], v[122:123], v[82:83] op_sel_hi:[0,1,1]
    v_pk_fma_f32 v[124:125], v[8:9], v[124:125], v[84:85] op_sel_hi:[0,1,1]
    v_pk_fma_f32 v[126:127], v[8:9], v[126:127], v[86:87] op_sel_hi:[0,1,1]
    v_pk_mul_f32 v[80:81], v[120:121], v[120:121]
    v_pk_mul_f32 v[82:83], v[122:123], v[122:123]
    v_pk_mul_f32 v[84:85], v[124:125], v[124:125]
    v_pk_mul_f32 v[86:87], v[126:127], v[126:127]
    v_pk_fma_f32 v[80:81], v[80:81], v[224:225], v[224:225] op_sel:[0,0,1] op_sel_hi:[1,0,1]
    v_pk_fma_f32 v[82:83], v[82:83], v[224:225], v[224:225] op_sel:[0,0,1] op_sel_hi:[1,0,1]
    v_pk_fma_f32 v[84:85], v[84:85], v[224:225], v[224:225] op_sel:[0,0,1] op_sel_hi:[1,0,1]
    v_pk_fma_f32 v[86:87], v[86:87], v[224:225], v[224:225] op_sel:[0,0,1] op_sel_hi:[1,0,1]
    v_pk_mul_f32 v[80:81], v[80:81], v[120:121]
    v_pk_mul_f32 v[82:83], v[82:83], v[122:123]
    v_pk_mul_f32 v[84:85], v[84:85], v[124:125]
    v_pk_mul_f32 v[86:87], v[86:87], v[126:127]
    v_exp_f32 v80, v80
    v_exp_f32 v81, v81
    v_exp_f32 v82, v82
    v_exp_f32 v83, v83
    v_exp_f32 v84, v84
    v_exp_f32 v85, v85
    v_exp_f32 v86, v86
    v_exp_f32 v87, v87
    v_pk_add_f32 v[80:81], v[80:81], v[226:227]
    v_pk_add_f32 v[82:83], v[82:83], v[226:227]
    v_pk_add_f32 v[84:85], v[84:85], v[226:227]
    v_pk_add_f32 v[86:87], v[86:87], v[226:227]
    v_rcp_f32 v80, v80
    v_rcp_f32 v81, v81
    v_rcp_f32 v82, v82
    v_rcp_f32 v83, v83
    v_rcp_f32 v84, v84
    v_rcp_f32 v85, v85
    v_rcp_f32 v86, v86
    v_rcp_f32 v87, v87
    v_pk_mul_f32 v[120:121], v[120:121], v[80:81]
    v_pk_mul_f32 v[122:123], v[122:123], v[82:83]
    v_pk_mul_f32 v[124:125], v[124:125], v[84:85]
    v_pk_mul_f32 v[126:127], v[126:127], v[86:87]
    v_cvt_pk_bf16_f32 v88, v120, v121
    v_cvt_pk_bf16_f32 v89, v122, v123
    v_cvt_pk_bf16_f32 v90, v124, v125
    v_cvt_pk_bf16_f32 v91, v126, v127
    buffer_store_dwordx4 v[88:91], v6, s[36:39], s84 offen offset:1024 sc1
    v_pk_fma_f32 v[96:97], v[10:11], v[24:25], v[56:57] op_sel:[1,0,0] op_sel_hi:[1,1,1] neg_lo:[1,0,0] neg_hi:[1,0,0]
    v_pk_fma_f32 v[98:99], v[10:11], v[26:27], v[58:59] op_sel:[1,0,0] op_sel_hi:[1,1,1] neg_lo:[1,0,0] neg_hi:[1,0,0]
    v_pk_fma_f32 v[100:101], v[10:11], v[28:29], v[60:61] op_sel:[1,0,0] op_sel_hi:[1,1,1] neg_lo:[1,0,0] neg_hi:[1,0,0]
    v_pk_fma_f32 v[102:103], v[10:11], v[30:31], v[62:63] op_sel:[1,0,0] op_sel_hi:[1,1,1] neg_lo:[1,0,0] neg_hi:[1,0,0]
    v_pk_fma_f32 v[144:145], v[10:11], v[144:145], v[96:97] op_sel_hi:[0,1,1]
    v_pk_fma_f32 v[146:147], v[10:11], v[146:147], v[98:99] op_sel_hi:[0,1,1]
    v_pk_fma_f32 v[148:149], v[10:11], v[148:149], v[100:101] op_sel_hi:[0,1,1]
    v_pk_fma_f32 v[150:151], v[10:11], v[150:151], v[102:103] op_sel_hi:[0,1,1]
    v_pk_mul_f32 v[96:97], v[144:145], v[144:145]
    v_pk_mul_f32 v[98:99], v[146:147], v[146:147]
    v_pk_mul_f32 v[100:101], v[148:149], v[148:149]
    v_pk_mul_f32 v[102:103], v[150:151], v[150:151]
    v_pk_fma_f32 v[96:97], v[96:97], v[224:225], v[224:225] op_sel:[0,0,1] op_sel_hi:[1,0,1]
    v_pk_fma_f32 v[98:99], v[98:99], v[224:225], v[224:225] op_sel:[0,0,1] op_sel_hi:[1,0,1]
    v_pk_fma_f32 v[100:101], v[100:101], v[224:225], v[224:225] op_sel:[0,0,1] op_sel_hi:[1,0,1]
    v_pk_fma_f32 v[102:103], v[102:103], v[224:225], v[224:225] op_sel:[0,0,1] op_sel_hi:[1,0,1]
    v_pk_mul_f32 v[96:97], v[96:97], v[144:145]
    v_pk_mul_f32 v[98:99], v[98:99], v[146:147]
    v_pk_mul_f32 v[100:101], v[100:101], v[148:149]
    v_pk_mul_f32 v[102:103], v[102:103], v[150:151]
    v_exp_f32 v96, v96
    v_exp_f32 v97, v97
    v_exp_f32 v98, v98
    v_exp_f32 v99, v99
    v_exp_f32 v100, v100
    v_exp_f32 v101, v101
    v_exp_f32 v102, v102
    v_exp_f32 v103, v103
    v_pk_add_f32 v[96:97], v[96:97], v[226:227]
    v_pk_add_f32 v[98:99], v[98:99], v[226:227]
    v_pk_add_f32 v[100:101], v[100:101], v[226:227]
    v_pk_add_f32 v[102:103], v[102:103], v[226:227]
    v_rcp_f32 v96, v96
    v_rcp_f32 v97, v97
    v_rcp_f32 v98, v98
    v_rcp_f32 v99, v99
    v_rcp_f32 v100, v100
    v_rcp_f32 v101, v101
    v_rcp_f32 v102, v102
    v_rcp_f32 v103, v103
    v_pk_mul_f32 v[144:145], v[144:145], v[96:97]
    v_pk_mul_f32 v[146:147], v[146:147], v[98:99]
    v_pk_mul_f32 v[148:149], v[148:149], v[100:101]
    v_pk_mul_f32 v[150:151], v[150:151], v[102:103]
    v_cvt_pk_bf16_f32 v104, v144, v145
    v_cvt_pk_bf16_f32 v105, v146, v147
    v_cvt_pk_bf16_f32 v106, v148, v149
    v_cvt_pk_bf16_f32 v107, v150, v151
    buffer_store_dwordx4 v[104:107], v6, s[36:39], s85 offen offset:1024 sc1
    v_pk_fma_f32 v[80:81], v[12:13], v[24:25], v[56:57] op_sel:[1,0,0] op_sel_hi:[1,1,1] neg_lo:[1,0,0] neg_hi:[1,0,0]
    v_pk_fma_f32 v[82:83], v[12:13], v[26:27], v[58:59] op_sel:[1,0,0] op_sel_hi:[1,1,1] neg_lo:[1,0,0] neg_hi:[1,0,0]
    v_pk_fma_f32 v[84:85], v[12:13], v[28:29], v[60:61] op_sel:[1,0,0] op_sel_hi:[1,1,1] neg_lo:[1,0,0] neg_hi:[1,0,0]
    v_pk_fma_f32 v[86:87], v[12:13], v[30:31], v[62:63] op_sel:[1,0,0] op_sel_hi:[1,1,1] neg_lo:[1,0,0] neg_hi:[1,0,0]
    v_pk_fma_f32 v[168:169], v[12:13], v[168:169], v[80:81] op_sel_hi:[0,1,1]
    v_pk_fma_f32 v[170:171], v[12:13], v[170:171], v[82:83] op_sel_hi:[0,1,1]
    v_pk_fma_f32 v[172:173], v[12:13], v[172:173], v[84:85] op_sel_hi:[0,1,1]
    v_pk_fma_f32 v[174:175], v[12:13], v[174:175], v[86:87] op_sel_hi:[0,1,1]
    v_pk_mul_f32 v[80:81], v[168:169], v[168:169]
    v_pk_mul_f32 v[82:83], v[170:171], v[170:171]
    v_pk_mul_f32 v[84:85], v[172:173], v[172:173]
    v_pk_mul_f32 v[86:87], v[174:175], v[174:175]
    v_pk_fma_f32 v[80:81], v[80:81], v[224:225], v[224:225] op_sel:[0,0,1] op_sel_hi:[1,0,1]
    v_pk_fma_f32 v[82:83], v[82:83], v[224:225], v[224:225] op_sel:[0,0,1] op_sel_hi:[1,0,1]
    v_pk_fma_f32 v[84:85], v[84:85], v[224:225], v[224:225] op_sel:[0,0,1] op_sel_hi:[1,0,1]
    v_pk_fma_f32 v[86:87], v[86:87], v[224:225], v[224:225] op_sel:[0,0,1] op_sel_hi:[1,0,1]
    v_pk_mul_f32 v[80:81], v[80:81], v[168:169]
    v_pk_mul_f32 v[82:83], v[82:83], v[170:171]
    v_pk_mul_f32 v[84:85], v[84:85], v[172:173]
    v_pk_mul_f32 v[86:87], v[86:87], v[174:175]
    v_exp_f32 v80, v80
    v_exp_f32 v81, v81
    v_exp_f32 v82, v82
    v_exp_f32 v83, v83
    v_exp_f32 v84, v84
    v_exp_f32 v85, v85
    v_exp_f32 v86, v86
    v_exp_f32 v87, v87
    v_pk_add_f32 v[80:81], v[80:81], v[226:227]
    v_pk_add_f32 v[82:83], v[82:83], v[226:227]
    v_pk_add_f32 v[84:85], v[84:85], v[226:227]
    v_pk_add_f32 v[86:87], v[86:87], v[226:227]
    v_rcp_f32 v80, v80
    v_rcp_f32 v81, v81
    v_rcp_f32 v82, v82
    v_rcp_f32 v83, v83
    v_rcp_f32 v84, v84
    v_rcp_f32 v85, v85
    v_rcp_f32 v86, v86
    v_rcp_f32 v87, v87
    v_pk_mul_f32 v[168:169], v[168:169], v[80:81]
    v_pk_mul_f32 v[170:171], v[170:171], v[82:83]
    v_pk_mul_f32 v[172:173], v[172:173], v[84:85]
    v_pk_mul_f32 v[174:175], v[174:175], v[86:87]
    v_cvt_pk_bf16_f32 v88, v168, v169
    v_cvt_pk_bf16_f32 v89, v170, v171
    v_cvt_pk_bf16_f32 v90, v172, v173
    v_cvt_pk_bf16_f32 v91, v174, v175
    buffer_store_dwordx4 v[88:91], v6, s[36:39], s86 offen offset:1024 sc1
    v_pk_fma_f32 v[96:97], v[14:15], v[24:25], v[56:57] op_sel:[1,0,0] op_sel_hi:[1,1,1] neg_lo:[1,0,0] neg_hi:[1,0,0]
    v_pk_fma_f32 v[98:99], v[14:15], v[26:27], v[58:59] op_sel:[1,0,0] op_sel_hi:[1,1,1] neg_lo:[1,0,0] neg_hi:[1,0,0]
    v_pk_fma_f32 v[100:101], v[14:15], v[28:29], v[60:61] op_sel:[1,0,0] op_sel_hi:[1,1,1] neg_lo:[1,0,0] neg_hi:[1,0,0]
    v_pk_fma_f32 v[102:103], v[14:15], v[30:31], v[62:63] op_sel:[1,0,0] op_sel_hi:[1,1,1] neg_lo:[1,0,0] neg_hi:[1,0,0]
    v_pk_fma_f32 v[192:193], v[14:15], v[192:193], v[96:97] op_sel_hi:[0,1,1]
    v_pk_fma_f32 v[194:195], v[14:15], v[194:195], v[98:99] op_sel_hi:[0,1,1]
    v_pk_fma_f32 v[196:197], v[14:15], v[196:197], v[100:101] op_sel_hi:[0,1,1]
    v_pk_fma_f32 v[198:199], v[14:15], v[198:199], v[102:103] op_sel_hi:[0,1,1]
    v_pk_mul_f32 v[96:97], v[192:193], v[192:193]
    v_pk_mul_f32 v[98:99], v[194:195], v[194:195]
    v_pk_mul_f32 v[100:101], v[196:197], v[196:197]
    v_pk_mul_f32 v[102:103], v[198:199], v[198:199]
    v_pk_fma_f32 v[96:97], v[96:97], v[224:225], v[224:225] op_sel:[0,0,1] op_sel_hi:[1,0,1]
    v_pk_fma_f32 v[98:99], v[98:99], v[224:225], v[224:225] op_sel:[0,0,1] op_sel_hi:[1,0,1]
    v_pk_fma_f32 v[100:101], v[100:101], v[224:225], v[224:225] op_sel:[0,0,1] op_sel_hi:[1,0,1]
    v_pk_fma_f32 v[102:103], v[102:103], v[224:225], v[224:225] op_sel:[0,0,1] op_sel_hi:[1,0,1]
    v_pk_mul_f32 v[96:97], v[96:97], v[192:193]
    v_pk_mul_f32 v[98:99], v[98:99], v[194:195]
    v_pk_mul_f32 v[100:101], v[100:101], v[196:197]
    v_pk_mul_f32 v[102:103], v[102:103], v[198:199]
    v_exp_f32 v96, v96
    v_exp_f32 v97, v97
    v_exp_f32 v98, v98
    v_exp_f32 v99, v99
    v_exp_f32 v100, v100
    v_exp_f32 v101, v101
    v_exp_f32 v102, v102
    v_exp_f32 v103, v103
    v_pk_add_f32 v[96:97], v[96:97], v[226:227]
    v_pk_add_f32 v[98:99], v[98:99], v[226:227]
    v_pk_add_f32 v[100:101], v[100:101], v[226:227]
    v_pk_add_f32 v[102:103], v[102:103], v[226:227]
    v_rcp_f32 v96, v96
    v_rcp_f32 v97, v97
    v_rcp_f32 v98, v98
    v_rcp_f32 v99, v99
    v_rcp_f32 v100, v100
    v_rcp_f32 v101, v101
    v_rcp_f32 v102, v102
    v_rcp_f32 v103, v103
    v_pk_mul_f32 v[192:193], v[192:193], v[96:97]
    v_pk_mul_f32 v[194:195], v[194:195], v[98:99]
    v_pk_mul_f32 v[196:197], v[196:197], v[100:101]
    v_pk_mul_f32 v[198:199], v[198:199], v[102:103]
    v_cvt_pk_bf16_f32 v104, v192, v193
    v_cvt_pk_bf16_f32 v105, v194, v195
    v_cvt_pk_bf16_f32 v106, v196, v197
    v_cvt_pk_bf16_f32 v107, v198, v199
    buffer_store_dwordx4 v[104:107], v6, s[36:39], s87 offen offset:1024 sc1
    v_pk_fma_f32 v[80:81], v[8:9], v[32:33], v[64:65] op_sel:[1,0,0] op_sel_hi:[1,1,1] neg_lo:[1,0,0] neg_hi:[1,0,0]
    v_pk_fma_f32 v[82:83], v[8:9], v[34:35], v[66:67] op_sel:[1,0,0] op_sel_hi:[1,1,1] neg_lo:[1,0,0] neg_hi:[1,0,0]
    v_pk_fma_f32 v[84:85], v[8:9], v[36:37], v[68:69] op_sel:[1,0,0] op_sel_hi:[1,1,1] neg_lo:[1,0,0] neg_hi:[1,0,0]
    v_pk_fma_f32 v[86:87], v[8:9], v[38:39], v[70:71] op_sel:[1,0,0] op_sel_hi:[1,1,1] neg_lo:[1,0,0] neg_hi:[1,0,0]
    v_pk_fma_f32 v[128:129], v[8:9], v[128:129], v[80:81] op_sel_hi:[0,1,1]
    v_pk_fma_f32 v[130:131], v[8:9], v[130:131], v[82:83] op_sel_hi:[0,1,1]
    v_pk_fma_f32 v[132:133], v[8:9], v[132:133], v[84:85] op_sel_hi:[0,1,1]
    v_pk_fma_f32 v[134:135], v[8:9], v[134:135], v[86:87] op_sel_hi:[0,1,1]
    v_pk_mul_f32 v[80:81], v[128:129], v[128:129]
    v_pk_mul_f32 v[82:83], v[130:131], v[130:131]
    v_pk_mul_f32 v[84:85], v[132:133], v[132:133]
    v_pk_mul_f32 v[86:87], v[134:135], v[134:135]
    v_pk_fma_f32 v[80:81], v[80:81], v[224:225], v[224:225] op_sel:[0,0,1] op_sel_hi:[1,0,1]
    v_pk_fma_f32 v[82:83], v[82:83], v[224:225], v[224:225] op_sel:[0,0,1] op_sel_hi:[1,0,1]
    v_pk_fma_f32 v[84:85], v[84:85], v[224:225], v[224:225] op_sel:[0,0,1] op_sel_hi:[1,0,1]
    v_pk_fma_f32 v[86:87], v[86:87], v[224:225], v[224:225] op_sel:[0,0,1] op_sel_hi:[1,0,1]
    v_pk_mul_f32 v[80:81], v[80:81], v[128:129]
    v_pk_mul_f32 v[82:83], v[82:83], v[130:131]
    v_pk_mul_f32 v[84:85], v[84:85], v[132:133]
    v_pk_mul_f32 v[86:87], v[86:87], v[134:135]
    v_exp_f32 v80, v80
    v_exp_f32 v81, v81
    v_exp_f32 v82, v82
    v_exp_f32 v83, v83
    v_exp_f32 v84, v84
    v_exp_f32 v85, v85
    v_exp_f32 v86, v86
    v_exp_f32 v87, v87
    v_pk_add_f32 v[80:81], v[80:81], v[226:227]
    v_pk_add_f32 v[82:83], v[82:83], v[226:227]
    v_pk_add_f32 v[84:85], v[84:85], v[226:227]
    v_pk_add_f32 v[86:87], v[86:87], v[226:227]
    v_rcp_f32 v80, v80
    v_rcp_f32 v81, v81
    v_rcp_f32 v82, v82
    v_rcp_f32 v83, v83
    v_rcp_f32 v84, v84
    v_rcp_f32 v85, v85
    v_rcp_f32 v86, v86
    v_rcp_f32 v87, v87
    v_pk_mul_f32 v[128:129], v[128:129], v[80:81]
    v_pk_mul_f32 v[130:131], v[130:131], v[82:83]
    v_pk_mul_f32 v[132:133], v[132:133], v[84:85]
    v_pk_mul_f32 v[134:135], v[134:135], v[86:87]
    v_cvt_pk_bf16_f32 v88, v128, v129
    v_cvt_pk_bf16_f32 v89, v130, v131
    v_cvt_pk_bf16_f32 v90, v132, v133
    v_cvt_pk_bf16_f32 v91, v134, v135
    buffer_store_dwordx4 v[88:91], v6, s[36:39], s84 offen offset:2048 sc1
    v_pk_fma_f32 v[96:97], v[10:11], v[32:33], v[64:65] op_sel:[1,0,0] op_sel_hi:[1,1,1] neg_lo:[1,0,0] neg_hi:[1,0,0]
    v_pk_fma_f32 v[98:99], v[10:11], v[34:35], v[66:67] op_sel:[1,0,0] op_sel_hi:[1,1,1] neg_lo:[1,0,0] neg_hi:[1,0,0]
    v_pk_fma_f32 v[100:101], v[10:11], v[36:37], v[68:69] op_sel:[1,0,0] op_sel_hi:[1,1,1] neg_lo:[1,0,0] neg_hi:[1,0,0]
    v_pk_fma_f32 v[102:103], v[10:11], v[38:39], v[70:71] op_sel:[1,0,0] op_sel_hi:[1,1,1] neg_lo:[1,0,0] neg_hi:[1,0,0]
    v_pk_fma_f32 v[152:153], v[10:11], v[152:153], v[96:97] op_sel_hi:[0,1,1]
    v_pk_fma_f32 v[154:155], v[10:11], v[154:155], v[98:99] op_sel_hi:[0,1,1]
    v_pk_fma_f32 v[156:157], v[10:11], v[156:157], v[100:101] op_sel_hi:[0,1,1]
    v_pk_fma_f32 v[158:159], v[10:11], v[158:159], v[102:103] op_sel_hi:[0,1,1]
    v_pk_mul_f32 v[96:97], v[152:153], v[152:153]
    v_pk_mul_f32 v[98:99], v[154:155], v[154:155]
    v_pk_mul_f32 v[100:101], v[156:157], v[156:157]
    v_pk_mul_f32 v[102:103], v[158:159], v[158:159]
    v_pk_fma_f32 v[96:97], v[96:97], v[224:225], v[224:225] op_sel:[0,0,1] op_sel_hi:[1,0,1]
    v_pk_fma_f32 v[98:99], v[98:99], v[224:225], v[224:225] op_sel:[0,0,1] op_sel_hi:[1,0,1]
    v_pk_fma_f32 v[100:101], v[100:101], v[224:225], v[224:225] op_sel:[0,0,1] op_sel_hi:[1,0,1]
    v_pk_fma_f32 v[102:103], v[102:103], v[224:225], v[224:225] op_sel:[0,0,1] op_sel_hi:[1,0,1]
    v_pk_mul_f32 v[96:97], v[96:97], v[152:153]
    v_pk_mul_f32 v[98:99], v[98:99], v[154:155]
    v_pk_mul_f32 v[100:101], v[100:101], v[156:157]
    v_pk_mul_f32 v[102:103], v[102:103], v[158:159]
    v_exp_f32 v96, v96
    v_exp_f32 v97, v97
    v_exp_f32 v98, v98
    v_exp_f32 v99, v99
    v_exp_f32 v100, v100
    v_exp_f32 v101, v101
    v_exp_f32 v102, v102
    v_exp_f32 v103, v103
    v_pk_add_f32 v[96:97], v[96:97], v[226:227]
    v_pk_add_f32 v[98:99], v[98:99], v[226:227]
    v_pk_add_f32 v[100:101], v[100:101], v[226:227]
    v_pk_add_f32 v[102:103], v[102:103], v[226:227]
    v_rcp_f32 v96, v96
    v_rcp_f32 v97, v97
    v_rcp_f32 v98, v98
    v_rcp_f32 v99, v99
    v_rcp_f32 v100, v100
    v_rcp_f32 v101, v101
    v_rcp_f32 v102, v102
    v_rcp_f32 v103, v103
    v_pk_mul_f32 v[152:153], v[152:153], v[96:97]
    v_pk_mul_f32 v[154:155], v[154:155], v[98:99]
    v_pk_mul_f32 v[156:157], v[156:157], v[100:101]
    v_pk_mul_f32 v[158:159], v[158:159], v[102:103]
    v_cvt_pk_bf16_f32 v104, v152, v153
    v_cvt_pk_bf16_f32 v105, v154, v155
    v_cvt_pk_bf16_f32 v106, v156, v157
    v_cvt_pk_bf16_f32 v107, v158, v159
    buffer_store_dwordx4 v[104:107], v6, s[36:39], s85 offen offset:2048 sc1
    v_pk_fma_f32 v[80:81], v[12:13], v[32:33], v[64:65] op_sel:[1,0,0] op_sel_hi:[1,1,1] neg_lo:[1,0,0] neg_hi:[1,0,0]
    v_pk_fma_f32 v[82:83], v[12:13], v[34:35], v[66:67] op_sel:[1,0,0] op_sel_hi:[1,1,1] neg_lo:[1,0,0] neg_hi:[1,0,0]
    v_pk_fma_f32 v[84:85], v[12:13], v[36:37], v[68:69] op_sel:[1,0,0] op_sel_hi:[1,1,1] neg_lo:[1,0,0] neg_hi:[1,0,0]
    v_pk_fma_f32 v[86:87], v[12:13], v[38:39], v[70:71] op_sel:[1,0,0] op_sel_hi:[1,1,1] neg_lo:[1,0,0] neg_hi:[1,0,0]
    v_pk_fma_f32 v[176:177], v[12:13], v[176:177], v[80:81] op_sel_hi:[0,1,1]
    v_pk_fma_f32 v[178:179], v[12:13], v[178:179], v[82:83] op_sel_hi:[0,1,1]
    v_pk_fma_f32 v[180:181], v[12:13], v[180:181], v[84:85] op_sel_hi:[0,1,1]
    v_pk_fma_f32 v[182:183], v[12:13], v[182:183], v[86:87] op_sel_hi:[0,1,1]
    v_pk_mul_f32 v[80:81], v[176:177], v[176:177]
    v_pk_mul_f32 v[82:83], v[178:179], v[178:179]
    v_pk_mul_f32 v[84:85], v[180:181], v[180:181]
    v_pk_mul_f32 v[86:87], v[182:183], v[182:183]
    v_pk_fma_f32 v[80:81], v[80:81], v[224:225], v[224:225] op_sel:[0,0,1] op_sel_hi:[1,0,1]
    v_pk_fma_f32 v[82:83], v[82:83], v[224:225], v[224:225] op_sel:[0,0,1] op_sel_hi:[1,0,1]
    v_pk_fma_f32 v[84:85], v[84:85], v[224:225], v[224:225] op_sel:[0,0,1] op_sel_hi:[1,0,1]
    v_pk_fma_f32 v[86:87], v[86:87], v[224:225], v[224:225] op_sel:[0,0,1] op_sel_hi:[1,0,1]
    v_pk_mul_f32 v[80:81], v[80:81], v[176:177]
    v_pk_mul_f32 v[82:83], v[82:83], v[178:179]
    v_pk_mul_f32 v[84:85], v[84:85], v[180:181]
    v_pk_mul_f32 v[86:87], v[86:87], v[182:183]
    v_exp_f32 v80, v80
    v_exp_f32 v81, v81
    v_exp_f32 v82, v82
    v_exp_f32 v83, v83
    v_exp_f32 v84, v84
    v_exp_f32 v85, v85
    v_exp_f32 v86, v86
    v_exp_f32 v87, v87
    v_pk_add_f32 v[80:81], v[80:81], v[226:227]
    v_pk_add_f32 v[82:83], v[82:83], v[226:227]
    v_pk_add_f32 v[84:85], v[84:85], v[226:227]
    v_pk_add_f32 v[86:87], v[86:87], v[226:227]
    v_rcp_f32 v80, v80
    v_rcp_f32 v81, v81
    v_rcp_f32 v82, v82
    v_rcp_f32 v83, v83
    v_rcp_f32 v84, v84
    v_rcp_f32 v85, v85
    v_rcp_f32 v86, v86
    v_rcp_f32 v87, v87
    v_pk_mul_f32 v[176:177], v[176:177], v[80:81]
    v_pk_mul_f32 v[178:179], v[178:179], v[82:83]
    v_pk_mul_f32 v[180:181], v[180:181], v[84:85]
    v_pk_mul_f32 v[182:183], v[182:183], v[86:87]
    v_cvt_pk_bf16_f32 v88, v176, v177
    v_cvt_pk_bf16_f32 v89, v178, v179
    v_cvt_pk_bf16_f32 v90, v180, v181
    v_cvt_pk_bf16_f32 v91, v182, v183
    buffer_store_dwordx4 v[88:91], v6, s[36:39], s86 offen offset:2048 sc1
    v_pk_fma_f32 v[96:97], v[14:15], v[32:33], v[64:65] op_sel:[1,0,0] op_sel_hi:[1,1,1] neg_lo:[1,0,0] neg_hi:[1,0,0]
    v_pk_fma_f32 v[98:99], v[14:15], v[34:35], v[66:67] op_sel:[1,0,0] op_sel_hi:[1,1,1] neg_lo:[1,0,0] neg_hi:[1,0,0]
    v_pk_fma_f32 v[100:101], v[14:15], v[36:37], v[68:69] op_sel:[1,0,0] op_sel_hi:[1,1,1] neg_lo:[1,0,0] neg_hi:[1,0,0]
    v_pk_fma_f32 v[102:103], v[14:15], v[38:39], v[70:71] op_sel:[1,0,0] op_sel_hi:[1,1,1] neg_lo:[1,0,0] neg_hi:[1,0,0]
    v_pk_fma_f32 v[200:201], v[14:15], v[200:201], v[96:97] op_sel_hi:[0,1,1]
    v_pk_fma_f32 v[202:203], v[14:15], v[202:203], v[98:99] op_sel_hi:[0,1,1]
    v_pk_fma_f32 v[204:205], v[14:15], v[204:205], v[100:101] op_sel_hi:[0,1,1]
    v_pk_fma_f32 v[206:207], v[14:15], v[206:207], v[102:103] op_sel_hi:[0,1,1]
    v_pk_mul_f32 v[96:97], v[200:201], v[200:201]
    v_pk_mul_f32 v[98:99], v[202:203], v[202:203]
    v_pk_mul_f32 v[100:101], v[204:205], v[204:205]
    v_pk_mul_f32 v[102:103], v[206:207], v[206:207]
    v_pk_fma_f32 v[96:97], v[96:97], v[224:225], v[224:225] op_sel:[0,0,1] op_sel_hi:[1,0,1]
    v_pk_fma_f32 v[98:99], v[98:99], v[224:225], v[224:225] op_sel:[0,0,1] op_sel_hi:[1,0,1]
    v_pk_fma_f32 v[100:101], v[100:101], v[224:225], v[224:225] op_sel:[0,0,1] op_sel_hi:[1,0,1]
    v_pk_fma_f32 v[102:103], v[102:103], v[224:225], v[224:225] op_sel:[0,0,1] op_sel_hi:[1,0,1]
    v_pk_mul_f32 v[96:97], v[96:97], v[200:201]
    v_pk_mul_f32 v[98:99], v[98:99], v[202:203]
    v_pk_mul_f32 v[100:101], v[100:101], v[204:205]
    v_pk_mul_f32 v[102:103], v[102:103], v[206:207]
    v_exp_f32 v96, v96
    v_exp_f32 v97, v97
    v_exp_f32 v98, v98
    v_exp_f32 v99, v99
    v_exp_f32 v100, v100
    v_exp_f32 v101, v101
    v_exp_f32 v102, v102
    v_exp_f32 v103, v103
    v_pk_add_f32 v[96:97], v[96:97], v[226:227]
    v_pk_add_f32 v[98:99], v[98:99], v[226:227]
    v_pk_add_f32 v[100:101], v[100:101], v[226:227]
    v_pk_add_f32 v[102:103], v[102:103], v[226:227]
    v_rcp_f32 v96, v96
    v_rcp_f32 v97, v97
    v_rcp_f32 v98, v98
    v_rcp_f32 v99, v99
    v_rcp_f32 v100, v100
    v_rcp_f32 v101, v101
    v_rcp_f32 v102, v102
    v_rcp_f32 v103, v103
    v_pk_mul_f32 v[200:201], v[200:201], v[96:97]
    v_pk_mul_f32 v[202:203], v[202:203], v[98:99]
    v_pk_mul_f32 v[204:205], v[204:205], v[100:101]
    v_pk_mul_f32 v[206:207], v[206:207], v[102:103]
    v_cvt_pk_bf16_f32 v104, v200, v201
    v_cvt_pk_bf16_f32 v105, v202, v203
    v_cvt_pk_bf16_f32 v106, v204, v205
    v_cvt_pk_bf16_f32 v107, v206, v207
    buffer_store_dwordx4 v[104:107], v6, s[36:39], s87 offen offset:2048 sc1
    v_pk_fma_f32 v[80:81], v[8:9], v[40:41], v[72:73] op_sel:[1,0,0] op_sel_hi:[1,1,1] neg_lo:[1,0,0] neg_hi:[1,0,0]
    v_pk_fma_f32 v[82:83], v[8:9], v[42:43], v[74:75] op_sel:[1,0,0] op_sel_hi:[1,1,1] neg_lo:[1,0,0] neg_hi:[1,0,0]
    v_pk_fma_f32 v[84:85], v[8:9], v[44:45], v[76:77] op_sel:[1,0,0] op_sel_hi:[1,1,1] neg_lo:[1,0,0] neg_hi:[1,0,0]
    v_pk_fma_f32 v[86:87], v[8:9], v[46:47], v[78:79] op_sel:[1,0,0] op_sel_hi:[1,1,1] neg_lo:[1,0,0] neg_hi:[1,0,0]
    v_pk_fma_f32 v[208:209], v[8:9], v[208:209], v[80:81] op_sel_hi:[0,1,1]
    v_pk_fma_f32 v[210:211], v[8:9], v[210:211], v[82:83] op_sel_hi:[0,1,1]
    v_pk_fma_f32 v[212:213], v[8:9], v[212:213], v[84:85] op_sel_hi:[0,1,1]
    v_pk_fma_f32 v[214:215], v[8:9], v[214:215], v[86:87] op_sel_hi:[0,1,1]
    v_pk_mul_f32 v[80:81], v[208:209], v[208:209]
    v_pk_mul_f32 v[82:83], v[210:211], v[210:211]
    v_pk_mul_f32 v[84:85], v[212:213], v[212:213]
    v_pk_mul_f32 v[86:87], v[214:215], v[214:215]
    v_pk_fma_f32 v[80:81], v[80:81], v[224:225], v[224:225] op_sel:[0,0,1] op_sel_hi:[1,0,1]
    v_pk_fma_f32 v[82:83], v[82:83], v[224:225], v[224:225] op_sel:[0,0,1] op_sel_hi:[1,0,1]
    v_pk_fma_f32 v[84:85], v[84:85], v[224:225], v[224:225] op_sel:[0,0,1] op_sel_hi:[1,0,1]
    v_pk_fma_f32 v[86:87], v[86:87], v[224:225], v[224:225] op_sel:[0,0,1] op_sel_hi:[1,0,1]
    v_pk_mul_f32 v[80:81], v[80:81], v[208:209]
    v_pk_mul_f32 v[82:83], v[82:83], v[210:211]
    v_pk_mul_f32 v[84:85], v[84:85], v[212:213]
    v_pk_mul_f32 v[86:87], v[86:87], v[214:215]
    v_exp_f32 v80, v80
    v_exp_f32 v81, v81
    v_exp_f32 v82, v82
    v_exp_f32 v83, v83
    v_exp_f32 v84, v84
    v_exp_f32 v85, v85
    v_exp_f32 v86, v86
    v_exp_f32 v87, v87
    v_pk_add_f32 v[80:81], v[80:81], v[226:227]
    v_pk_add_f32 v[82:83], v[82:83], v[226:227]
    v_pk_add_f32 v[84:85], v[84:85], v[226:227]
    v_pk_add_f32 v[86:87], v[86:87], v[226:227]
    v_rcp_f32 v80, v80
    v_rcp_f32 v81, v81
    v_rcp_f32 v82, v82
    v_rcp_f32 v83, v83
    v_rcp_f32 v84, v84
    v_rcp_f32 v85, v85
    v_rcp_f32 v86, v86
    v_rcp_f32 v87, v87
    v_pk_mul_f32 v[208:209], v[208:209], v[80:81]
    v_pk_mul_f32 v[210:211], v[210:211], v[82:83]
    v_pk_mul_f32 v[212:213], v[212:213], v[84:85]
    v_pk_mul_f32 v[214:215], v[214:215], v[86:87]
    v_cvt_pk_bf16_f32 v88, v208, v209
    v_cvt_pk_bf16_f32 v89, v210, v211
    v_cvt_pk_bf16_f32 v90, v212, v213
    v_cvt_pk_bf16_f32 v91, v214, v215
    buffer_store_dwordx4 v[88:91], v7, s[36:39], s84 offen sc1
    v_pk_fma_f32 v[96:97], v[10:11], v[40:41], v[72:73] op_sel:[1,0,0] op_sel_hi:[1,1,1] neg_lo:[1,0,0] neg_hi:[1,0,0]
    v_pk_fma_f32 v[98:99], v[10:11], v[42:43], v[74:75] op_sel:[1,0,0] op_sel_hi:[1,1,1] neg_lo:[1,0,0] neg_hi:[1,0,0]
    v_pk_fma_f32 v[100:101], v[10:11], v[44:45], v[76:77] op_sel:[1,0,0] op_sel_hi:[1,1,1] neg_lo:[1,0,0] neg_hi:[1,0,0]
    v_pk_fma_f32 v[102:103], v[10:11], v[46:47], v[78:79] op_sel:[1,0,0] op_sel_hi:[1,1,1] neg_lo:[1,0,0] neg_hi:[1,0,0]
    v_pk_fma_f32 v[216:217], v[10:11], v[216:217], v[96:97] op_sel_hi:[0,1,1]
    v_pk_fma_f32 v[218:219], v[10:11], v[218:219], v[98:99] op_sel_hi:[0,1,1]
    v_pk_fma_f32 v[220:221], v[10:11], v[220:221], v[100:101] op_sel_hi:[0,1,1]
    v_pk_fma_f32 v[222:223], v[10:11], v[222:223], v[102:103] op_sel_hi:[0,1,1]
    v_pk_mul_f32 v[96:97], v[216:217], v[216:217]
    v_pk_mul_f32 v[98:99], v[218:219], v[218:219]
    v_pk_mul_f32 v[100:101], v[220:221], v[220:221]
    v_pk_mul_f32 v[102:103], v[222:223], v[222:223]
    v_pk_fma_f32 v[96:97], v[96:97], v[224:225], v[224:225] op_sel:[0,0,1] op_sel_hi:[1,0,1]
    v_pk_fma_f32 v[98:99], v[98:99], v[224:225], v[224:225] op_sel:[0,0,1] op_sel_hi:[1,0,1]
    v_pk_fma_f32 v[100:101], v[100:101], v[224:225], v[224:225] op_sel:[0,0,1] op_sel_hi:[1,0,1]
    v_pk_fma_f32 v[102:103], v[102:103], v[224:225], v[224:225] op_sel:[0,0,1] op_sel_hi:[1,0,1]
    v_pk_mul_f32 v[96:97], v[96:97], v[216:217]
    v_pk_mul_f32 v[98:99], v[98:99], v[218:219]
    v_pk_mul_f32 v[100:101], v[100:101], v[220:221]
    v_pk_mul_f32 v[102:103], v[102:103], v[222:223]
    v_exp_f32 v96, v96
    v_exp_f32 v97, v97
    v_exp_f32 v98, v98
    v_exp_f32 v99, v99
    v_exp_f32 v100, v100
    v_exp_f32 v101, v101
    v_exp_f32 v102, v102
    v_exp_f32 v103, v103
    v_pk_add_f32 v[96:97], v[96:97], v[226:227]
    v_pk_add_f32 v[98:99], v[98:99], v[226:227]
    v_pk_add_f32 v[100:101], v[100:101], v[226:227]
    v_pk_add_f32 v[102:103], v[102:103], v[226:227]
    v_rcp_f32 v96, v96
    v_rcp_f32 v97, v97
    v_rcp_f32 v98, v98
    v_rcp_f32 v99, v99
    v_rcp_f32 v100, v100
    v_rcp_f32 v101, v101
    v_rcp_f32 v102, v102
    v_rcp_f32 v103, v103
    v_pk_mul_f32 v[216:217], v[216:217], v[96:97]
    v_pk_mul_f32 v[218:219], v[218:219], v[98:99]
    v_pk_mul_f32 v[220:221], v[220:221], v[100:101]
    v_pk_mul_f32 v[222:223], v[222:223], v[102:103]
    v_cvt_pk_bf16_f32 v104, v216, v217
    v_cvt_pk_bf16_f32 v105, v218, v219
    v_cvt_pk_bf16_f32 v106, v220, v221
    v_cvt_pk_bf16_f32 v107, v222, v223
    buffer_store_dwordx4 v[104:107], v7, s[36:39], s85 offen sc1
    s_lshl_b32 s63, s44, 7
    s_lshl_b32 s53, s45, 2
    s_add_u32 s63, s63, s53
    s_add_u32 s63, s63, 16384
    v_mov_b32 v236, 137984
    v_mov_b32 v237, 1
    v_mov_b32 v238, 0
    v_mov_b32 v239, s62
    s_mov_b64 exec, 1
    s_waitcnt vmcnt(0)
    ds_add_rtn_u32 v237, v236, v237
    s_waitcnt lgkmcnt(0)
    v_cmp_ne_u32 vcc, 3, v237
    s_cbranch_vccnz nopub_9
    buffer_store_dword v239, v238, s[96:99], s63 offen sc1
nopub_9:
    s_mov_b64 exec, -1
    s_barrier
    s_and_b32 s53, s2, 3
    s_lshl_b32 s53, s53, 2
    s_lshr_b32 s54, s2, 3
    s_and_b32 s55, s54, 3
    s_add_u32 s44, s53, s55
    s_bfe_u32 s46, s2, 0x10002
    s_lshr_b32 s45, s2, 5
    s_add_u32 s47, s44, s45
    s_and_b32 s47, s47, 3
    s_add_u32 s36, s24, 8388608
    s_addc_u32 s37, s25, 0
    s_mov_b32 s38, 4194304
    s_mov_b32 s39, 0x20000
    s_mov_b32 s40, s18
    s_mov_b32 s41, s19
    s_mov_b32 s42, 2048
    s_mov_b32 s43, 0x20000
    s_lshr_b32 s53, s27, 1
    s_and_b32 s54, s27, 1
    s_lshl_b32 s83, s45, 2
    s_lshl_b32 s55, s46, 1
    s_add_u32 s83, s83, s55
    s_add_u32 s83, s83, s54
    s_lshl_b32 s82, s44, 3
    s_lshl_b32 s55, s53, 2
    s_add_u32 s82, s82, s55
    v_lshlrev_b32 v3, 4, v0
    v_lshrrev_b32 v8, 4, v0
    v_lshlrev_b32 v8, 3, v8
    s_lshl_b32 s56, s83, 6
    buffer_load_dwordx2 v[96:97], v8, s[40:43], s56 offen
    buffer_load_dwordx2 v[98:99], v8, s[40:43], s56 offen offset:32
    s_lshl_b32 s55, s53, 13
    v_add_u32 v2, s55, v3
    s_lshl_b32 s55, s54, 1
    s_add_u32 s55, s55, 0
    v_lshrrev_b32 v10, 2, v0
    v_bfe_u32 v11, v0, 3, 2
    v_xor_b32 v11, s55, v11
    v_lshlrev_b32 v11, 5, v11
    v_lshlrev_b32 v10, 7, v10
    v_add_u32 v4, v10, v11
    v_and_b32 v10, 3, v0
    v_lshlrev_b32 v10, 3, v10
    v_add_u32 v4, v4, v10
    s_lshl_b32 s55, s46, 13
    s_add_u32 s55, s55, 16384
    v_add_u32 v4, s55, v4
    v_xor_b32 v6, 0x2000, v4
    s_lshl_b32 s55, s54, 1
    s_add_u32 s55, s55, 1
    v_lshrrev_b32 v10, 2, v0
    v_bfe_u32 v11, v0, 3, 2
    v_xor_b32 v11, s55, v11
    v_lshlrev_b32 v11, 5, v11
    v_lshlrev_b32 v10, 7, v10
    v_add_u32 v5, v10, v11
    v_and_b32 v10, 3, v0
    v_lshlrev_b32 v10, 3, v10
    v_add_u32 v5, v5, v10
    s_lshl_b32 s55, s46, 13
    s_add_u32 s55, s55, 16384
    v_add_u32 v5, s55, v5
    v_xor_b32 v7, 0x2000, v5
    s_mov_b32 s51, 0
    s_mov_b32 s52, 26
    s_mov_b32 s54, 0xffff0000
    s_mov_b32 s55, 32768
    s_barrier
    ds_read_b128 v[16:19], v2 offset:0
    ds_read_b128 v[20:23], v2 offset:2048
    ds_read_b128 v[24:27], v2 offset:4096
    ds_read_b128 v[28:31], v2 offset:6144
    ds_read_b64_tr_b16 v[48:49], v4 offset:0
    ds_read_b64_tr_b16 v[50:51], v4 offset:2048
    ds_read_b64_tr_b16 v[52:53], v5 offset:0
    ds_read_b64_tr_b16 v[54:55], v5 offset:2048
    ds_read_b64_tr_b16 v[56:57], v6 offset:0
    ds_read_b64_tr_b16 v[58:59], v6 offset:2048
    ds_read_b64_tr_b16 v[60:61], v7 offset:0
    ds_read_b64_tr_b16 v[62:63], v7 offset:2048
    s_lshl_b32 s84, s82, 15
    s_lshl_b32 s85, s83, 10
    s_add_u32 s84, s84, s85
    s_add_u32 s85, s84, 0
    buffer_load_dwordx4 v[80:83], v3, s[36:39], s85 offen sc1
    s_add_u32 s85, s84, 32768
    buffer_load_dwordx4 v[84:87], v3, s[36:39], s85 offen sc1
    s_add_u32 s85, s84, 65536
    buffer_load_dwordx4 v[88:91], v3, s[36:39], s85 offen sc1
    s_add_u32 s85, s84, 98304
    buffer_load_dwordx4 v[92:95], v3, s[36:39], s85 offen sc1
    s_add_u32 s32, s24, 33554432
    s_addc_u32 s33, s25, 0
    s_mov_b32 s34, 8388608
    s_mov_b32 s35, 0x20000
    s_mov_b32 s28, s20
    s_mov_b32 s29, s21
    s_mov_b32 s30, 4194304
    s_mov_b32 s31, 0x20000
    s_lshl_b32 s53, s44, 3
    s_add_u32 s53, s53, s45
    s_lshl_b32 s53, s53, 1
    s_add_u32 s53, s53, s46
    s_lshl_b32 s56, s53, 2
    s_add_u32 s56, s56, s27
    s_lshl_b32 s86, s56, 12
    s_xor_b32 s88, s86, 0x4000
    s_lshl_b32 s90, s56, 7
    s_add_u32 s90, s90, 65536
    s_xor_b32 s91, s90, 0x200
    v_mov_b32 v8, 0
    v_mov_b32 v9, s62
    v_and_b32 v10, 15, v0
    v_lshlrev_b32 v10, 11, v10
    v_bfe_u32 v11, v0, 4, 1
    v_lshl_add_u32 v10, v11, 5, v10
    v_bfe_u32 v11, v0, 5, 1
    v_lshl_add_u32 v10, v11, 4, v10
    s_lshl_b32 s80, s82, 15
    s_lshl_b32 s81, s83, 6
    s_add_u32 s80, s80, s81
    s_waitcnt lgkmcnt(0)
    v_mfma_f32_16x16x32_bf16 v[112:115], v[48:51], v[16:19], 0
    ds_read_b128 v[32:35], v2 offset:1024
    ds_read_b128 v[36:39], v2 offset:3072
    v_mfma_f32_16x16x32_bf16 v[116:119], v[52:55], v[16:19], 0
    ds_read_b128 v[40:43], v2 offset:5120
    v_mfma_f32_16x16x32_bf16 v[120:123], v[56:59], v[16:19], 0
    ds_read_b128 v[44:47], v2 offset:7168
    v_mfma_f32_16x16x32_bf16 v[124:127], v[60:63], v[16:19], 0
    ds_read_b64_tr_b16 v[64:65], v4 offset:4096
    v_mfma_f32_16x16x32_bf16 v[140:143], v[60:63], v[20:23], 0
    ds_read_b64_tr_b16 v[66:67], v4 offset:6144
    v_mfma_f32_16x16x32_bf16 v[136:139], v[56:59], v[20:23], 0
    ds_read_b64_tr_b16 v[68:69], v5 offset:4096
    ds_read_b64_tr_b16 v[70:71], v5 offset:6144
    v_mfma_f32_16x16x32_bf16 v[132:135], v[52:55], v[20:23], 0
    ds_read_b64_tr_b16 v[72:73], v6 offset:4096
    v_mfma_f32_16x16x32_bf16 v[128:131], v[48:51], v[20:23], 0
    ds_read_b64_tr_b16 v[74:75], v6 offset:6144
    v_mfma_f32_16x16x32_bf16 v[144:147], v[48:51], v[24:27], 0
    ds_read_b64_tr_b16 v[76:77], v7 offset:4096
    v_mfma_f32_16x16x32_bf16 v[148:151], v[52:55], v[24:27], 0
    ds_read_b64_tr_b16 v[78:79], v7 offset:6144
    v_mfma_f32_16x16x32_bf16 v[152:155], v[56:59], v[24:27], 0
    s_add_u32 s51, s51, 32768
    s_cmp_ge_u32 s51, 98304
    v_mfma_f32_16x16x32_bf16 v[156:159], v[60:63], v[24:27], 0
    s_cselect_b32 s51, 0, s51
    s_cselect_b32 s53, s54, s55
    v_mfma_f32_16x16x32_bf16 v[172:175], v[60:63], v[28:31], 0
    v_add_u32 v2, s53, v2
    v_add_u32 v4, s53, v4
    v_mfma_f32_16x16x32_bf16 v[168:171], v[56:59], v[28:31], 0
    v_add_u32 v5, s53, v5
    v_add_u32 v6, s53, v6
    v_mfma_f32_16x16x32_bf16 v[164:167], v[52:55], v[28:31], 0
    v_add_u32 v7, s53, v7
    v_mfma_f32_16x16x32_bf16 v[160:163], v[48:51], v[28:31], 0
cloop_10:
    s_waitcnt lgkmcnt(0)
    v_mfma_f32_16x16x32_bf16 v[112:115], v[64:67], v[32:35], v[112:115]
    v_mfma_f32_16x16x32_bf16 v[116:119], v[68:71], v[32:35], v[116:119]
    s_barrier
    v_mfma_f32_16x16x32_bf16 v[120:123], v[72:75], v[32:35], v[120:123]
    ds_read_b128 v[16:19], v2 offset:0
    v_mfma_f32_16x16x32_bf16 v[124:127], v[76:79], v[32:35], v[124:127]
    ds_read_b128 v[20:23], v2 offset:2048
    v_mfma_f32_16x16x32_bf16 v[140:143], v[76:79], v[36:39], v[140:143]
    ds_read_b128 v[24:27], v2 offset:4096
    v_mfma_f32_16x16x32_bf16 v[136:139], v[72:75], v[36:39], v[136:139]
    ds_read_b128 v[28:31], v2 offset:6144
    v_mfma_f32_16x16x32_bf16 v[132:135], v[68:71], v[36:39], v[132:135]
    ds_read_b64_tr_b16 v[48:49], v4 offset:0
    v_mfma_f32_16x16x32_bf16 v[128:131], v[64:67], v[36:39], v[128:131]
    ds_read_b64_tr_b16 v[50:51], v4 offset:2048
    v_mfma_f32_16x16x32_bf16 v[144:147], v[64:67], v[40:43], v[144:147]
    ds_read_b64_tr_b16 v[52:53], v5 offset:0
    v_mfma_f32_16x16x32_bf16 v[148:151], v[68:71], v[40:43], v[148:151]
    ds_read_b64_tr_b16 v[54:55], v5 offset:2048
    v_mfma_f32_16x16x32_bf16 v[152:155], v[72:75], v[40:43], v[152:155]
    ds_read_b64_tr_b16 v[56:57], v6 offset:0
    v_mfma_f32_16x16x32_bf16 v[156:159], v[76:79], v[40:43], v[156:159]
    ds_read_b64_tr_b16 v[58:59], v6 offset:2048
    v_mfma_f32_16x16x32_bf16 v[172:175], v[76:79], v[44:47], v[172:175]
    ds_read_b64_tr_b16 v[60:61], v7 offset:0
    v_mfma_f32_16x16x32_bf16 v[168:171], v[72:75], v[44:47], v[168:171]
    ds_read_b64_tr_b16 v[62:63], v7 offset:2048
    v_mfma_f32_16x16x32_bf16 v[164:167], v[68:71], v[44:47], v[164:167]
    v_mfma_f32_16x16x32_bf16 v[160:163], v[64:67], v[44:47], v[160:163]
    s_waitcnt lgkmcnt(0)
    v_mfma_f32_16x16x32_bf16 v[112:115], v[48:51], v[16:19], v[112:115]
    ds_read_b128 v[32:35], v2 offset:1024
    ds_read_b128 v[36:39], v2 offset:3072
    v_mfma_f32_16x16x32_bf16 v[116:119], v[52:55], v[16:19], v[116:119]
    ds_read_b128 v[40:43], v2 offset:5120
    v_mfma_f32_16x16x32_bf16 v[120:123], v[56:59], v[16:19], v[120:123]
    ds_read_b128 v[44:47], v2 offset:7168
    v_mfma_f32_16x16x32_bf16 v[124:127], v[60:63], v[16:19], v[124:127]
    ds_read_b64_tr_b16 v[64:65], v4 offset:4096
    v_mfma_f32_16x16x32_bf16 v[140:143], v[60:63], v[20:23], v[140:143]
    ds_read_b64_tr_b16 v[66:67], v4 offset:6144
    v_mfma_f32_16x16x32_bf16 v[136:139], v[56:59], v[20:23], v[136:139]
    ds_read_b64_tr_b16 v[68:69], v5 offset:4096
    ds_read_b64_tr_b16 v[70:71], v5 offset:6144
    v_mfma_f32_16x16x32_bf16 v[132:135], v[52:55], v[20:23], v[132:135]
    ds_read_b64_tr_b16 v[72:73], v6 offset:4096
    v_mfma_f32_16x16x32_bf16 v[128:131], v[48:51], v[20:23], v[128:131]
    ds_read_b64_tr_b16 v[74:75], v6 offset:6144
    v_mfma_f32_16x16x32_bf16 v[144:147], v[48:51], v[24:27], v[144:147]
    ds_read_b64_tr_b16 v[76:77], v7 offset:4096
    v_mfma_f32_16x16x32_bf16 v[148:151], v[52:55], v[24:27], v[148:151]
    ds_read_b64_tr_b16 v[78:79], v7 offset:6144
    v_mfma_f32_16x16x32_bf16 v[152:155], v[56:59], v[24:27], v[152:155]
    s_add_u32 s51, s51, 32768
    s_cmp_ge_u32 s51, 98304
    v_mfma_f32_16x16x32_bf16 v[156:159], v[60:63], v[24:27], v[156:159]
    s_cselect_b32 s51, 0, s51
    s_cselect_b32 s53, s54, s55
    v_mfma_f32_16x16x32_bf16 v[172:175], v[60:63], v[28:31], v[172:175]
    v_add_u32 v2, s53, v2
    v_add_u32 v4, s53, v4
    v_mfma_f32_16x16x32_bf16 v[168:171], v[56:59], v[28:31], v[168:171]
    v_add_u32 v5, s53, v5
    v_add_u32 v6, s53, v6
    v_mfma_f32_16x16x32_bf16 v[164:167], v[52:55], v[28:31], v[164:167]
    v_add_u32 v7, s53, v7
    v_mfma_f32_16x16x32_bf16 v[160:163], v[48:51], v[28:31], v[160:163]
    s_sub_u32 s52, s52, 1
    s_cbranch_scc0 cloop_10
    s_waitcnt lgkmcnt(0)
    v_mfma_f32_16x16x32_bf16 v[112:115], v[64:67], v[32:35], v[112:115]
    v_mfma_f32_16x16x32_bf16 v[116:119], v[68:71], v[32:35], v[116:119]
    s_barrier
    v_mfma_f32_16x16x32_bf16 v[120:123], v[72:75], v[32:35], v[120:123]
    v_mfma_f32_16x16x32_bf16 v[124:127], v[76:79], v[32:35], v[124:127]
    v_mfma_f32_16x16x32_bf16 v[140:143], v[76:79], v[36:39], v[140:143]
    v_mfma_f32_16x16x32_bf16 v[136:139], v[72:75], v[36:39], v[136:139]
    v_mfma_f32_16x16x32_bf16 v[132:135], v[68:71], v[36:39], v[132:135]
    v_mfma_f32_16x16x32_bf16 v[128:131], v[64:67], v[36:39], v[128:131]
    v_mfma_f32_16x16x32_bf16 v[144:147], v[64:67], v[40:43], v[144:147]
    v_mfma_f32_16x16x32_bf16 v[148:151], v[68:71], v[40:43], v[148:151]
    v_mfma_f32_16x16x32_bf16 v[152:155], v[72:75], v[40:43], v[152:155]
    v_mfma_f32_16x16x32_bf16 v[156:159], v[76:79], v[40:43], v[156:159]
    v_mfma_f32_16x16x32_bf16 v[172:175], v[76:79], v[44:47], v[172:175]
    v_mfma_f32_16x16x32_bf16 v[168:171], v[72:75], v[44:47], v[168:171]
    v_mfma_f32_16x16x32_bf16 v[164:167], v[68:71], v[44:47], v[164:167]
    v_mfma_f32_16x16x32_bf16 v[160:163], v[64:67], v[44:47], v[160:163]
    s_nop 7
    v_cvt_pk_bf16_f32 v64, v120, v121
    v_cvt_pk_bf16_f32 v65, v122, v123
    v_cvt_pk_bf16_f32 v66, v124, v125
    v_cvt_pk_bf16_f32 v67, v126, v127
    buffer_store_dwordx4 v[64:67], v3, s[32:35], s86 offen offset:0 sc1
    v_cvt_pk_bf16_f32 v68, v136, v137
    v_cvt_pk_bf16_f32 v69, v138, v139
    v_cvt_pk_bf16_f32 v70, v140, v141
    v_cvt_pk_bf16_f32 v71, v142, v143
    buffer_store_dwordx4 v[68:71], v3, s[32:35], s86 offen offset:1024 sc1
    v_cvt_pk_bf16_f32 v72, v152, v153
    v_cvt_pk_bf16_f32 v73, v154, v155
    v_cvt_pk_bf16_f32 v74, v156, v157
    v_cvt_pk_bf16_f32 v75, v158, v159
    buffer_store_dwordx4 v[72:75], v3, s[32:35], s86 offen offset:2048 sc1
    v_cvt_pk_bf16_f32 v76, v168, v169
    v_cvt_pk_bf16_f32 v77, v170, v171
    v_cvt_pk_bf16_f32 v78, v172, v173
    v_cvt_pk_bf16_f32 v79, v174, v175
    buffer_store_dwordx4 v[76:79], v3, s[32:35], s86 offen offset:3072 sc1
    s_waitcnt vmcnt(4)
    v_lshlrev_b32 v100, 16, v96
    v_and_b32 v101, 0xffff0000, v96
    v_lshlrev_b32 v102, 16, v97
    v_and_b32 v103, 0xffff0000, v97
    v_lshlrev_b32 v104, 16, v98
    v_and_b32 v105, 0xffff0000, v98
    v_lshlrev_b32 v106, 16, v99
    v_and_b32 v107, 0xffff0000, v99
    v_lshlrev_b32 v56, 16, v80
    v_and_b32 v57, 0xffff0000, v80
    v_lshlrev_b32 v58, 16, v81
    v_and_b32 v59, 0xffff0000, v81
    v_lshlrev_b32 v60, 16, v82
    v_and_b32 v61, 0xffff0000, v82
    v_lshlrev_b32 v62, 16, v83
    v_and_b32 v63, 0xffff0000, v83
    v_pk_add_f32 v[56:57], v[56:57], v[100:101]
    v_pk_add_f32 v[58:59], v[58:59], v[102:103]
    v_pk_add_f32 v[60:61], v[60:61], v[104:105]
    v_pk_add_f32 v[62:63], v[62:63], v[106:107]
    v_pk_add_f32 v[112:113], v[112:113], v[56:57]
    v_pk_add_f32 v[114:115], v[114:115], v[58:59]
    v_pk_add_f32 v[116:117], v[116:117], v[60:61]
    v_pk_add_f32 v[118:119], v[118:119], v[62:63]
    v_lshlrev_b32 v56, 16, v84
    v_and_b32 v57, 0xffff0000, v84
    v_lshlrev_b32 v58, 16, v85
    v_and_b32 v59, 0xffff0000, v85
    v_lshlrev_b32 v60, 16, v86
    v_and_b32 v61, 0xffff0000, v86
    v_lshlrev_b32 v62, 16, v87
    v_and_b32 v63, 0xffff0000, v87
    v_pk_add_f32 v[56:57], v[56:57], v[100:101]
    v_pk_add_f32 v[58:59], v[58:59], v[102:103]
    v_pk_add_f32 v[60:61], v[60:61], v[104:105]
    v_pk_add_f32 v[62:63], v[62:63], v[106:107]
    v_pk_add_f32 v[128:129], v[128:129], v[56:57]
    v_pk_add_f32 v[130:131], v[130:131], v[58:59]
    v_pk_add_f32 v[132:133], v[132:133], v[60:61]
    v_pk_add_f32 v[134:135], v[134:135], v[62:63]
    v_lshlrev_b32 v56, 16, v88
    v_and_b32 v57, 0xffff0000, v88
    v_lshlrev_b32 v58, 16, v89
    v_and_b32 v59, 0xffff0000, v89
    v_lshlrev_b32 v60, 16, v90
    v_and_b32 v61, 0xffff0000, v90
    v_lshlrev_b32 v62, 16, v91
    v_and_b32 v63, 0xffff0000, v91
    v_pk_add_f32 v[56:57], v[56:57], v[100:101]
    v_pk_add_f32 v[58:59], v[58:59], v[102:103]
    v_pk_add_f32 v[60:61], v[60:61], v[104:105]
    v_pk_add_f32 v[62:63], v[62:63], v[106:107]
    v_pk_add_f32 v[144:145], v[144:145], v[56:57]
    v_pk_add_f32 v[146:147], v[146:147], v[58:59]
    v_pk_add_f32 v[148:149], v[148:149], v[60:61]
    v_pk_add_f32 v[150:151], v[150:151], v[62:63]
    v_lshlrev_b32 v56, 16, v92
    v_and_b32 v57, 0xffff0000, v92
    v_lshlrev_b32 v58, 16, v93
    v_and_b32 v59, 0xffff0000, v93
    v_lshlrev_b32 v60, 16, v94
    v_and_b32 v61, 0xffff0000, v94
    v_lshlrev_b32 v62, 16, v95
    v_and_b32 v63, 0xffff0000, v95
    v_pk_add_f32 v[56:57], v[56:57], v[100:101]
    v_pk_add_f32 v[58:59], v[58:59], v[102:103]
    v_pk_add_f32 v[60:61], v[60:61], v[104:105]
    v_pk_add_f32 v[62:63], v[62:63], v[106:107]
    v_pk_add_f32 v[160:161], v[160:161], v[56:57]
    v_pk_add_f32 v[162:163], v[162:163], v[58:59]
    v_pk_add_f32 v[164:165], v[164:165], v[60:61]
    v_pk_add_f32 v[166:167], v[166:167], v[62:63]
    s_waitcnt vmcnt(0)
    s_mov_b64 exec, 1
    buffer_store_dword v9, v8, s[96:99], s90 offen sc1
    s_mov_b32 s81, 0
xp_11:
    buffer_load_dword v12, v8, s[96:99], s91 offen sc1
    s_add_u32 s81, s81, 1
    s_cmp_gt_u32 s81, 0x20000
    s_cbranch_scc1 xp_11_x
    s_waitcnt vmcnt(0)
    v_cmp_ne_u32 vcc, s62, v12
    s_cbranch_vccnz xp_11
xp_11_x:
    s_mov_b64 exec, -1
    buffer_load_dwordx4 v[24:27], v3, s[32:35], s88 offen offset:0 sc1
    buffer_load_dwordx4 v[28:31], v3, s[32:35], s88 offen offset:1024 sc1
    buffer_load_dwordx4 v[32:35], v3, s[32:35], s88 offen offset:2048 sc1
    buffer_load_dwordx4 v[36:39], v3, s[32:35], s88 offen offset:3072 sc1
    s_waitcnt vmcnt(3)
    v_lshlrev_b32 v56, 16, v24
    v_and_b32 v57, 0xffff0000, v24
    v_lshlrev_b32 v58, 16, v25
    v_and_b32 v59, 0xffff0000, v25
    v_lshlrev_b32 v60, 16, v26
    v_and_b32 v61, 0xffff0000, v26
    v_lshlrev_b32 v62, 16, v27
    v_and_b32 v63, 0xffff0000, v27
    v_pk_add_f32 v[112:113], v[112:113], v[56:57]
    v_pk_add_f32 v[114:115], v[114:115], v[58:59]
    v_pk_add_f32 v[116:117], v[116:117], v[60:61]
    v_pk_add_f32 v[118:119], v[118:119], v[62:63]
    v_cvt_pk_bf16_f32 v64, v112, v113
    v_cvt_pk_bf16_f32 v65, v114, v115
    v_cvt_pk_bf16_f32 v66, v116, v117
    v_cvt_pk_bf16_f32 v67, v118, v119
    s_add_u32 s81, s80, 0
    s_nop 0
    v_permlane16_swap_b32 v64, v66
    v_permlane16_swap_b32 v65, v67
    buffer_store_dwordx4 v[64:67], v10, s[28:31], s81 offen
    s_waitcnt vmcnt(3)
    v_lshlrev_b32 v56, 16, v28
    v_and_b32 v57, 0xffff0000, v28
    v_lshlrev_b32 v58, 16, v29
    v_and_b32 v59, 0xffff0000, v29
    v_lshlrev_b32 v60, 16, v30
    v_and_b32 v61, 0xffff0000, v30
    v_lshlrev_b32 v62, 16, v31
    v_and_b32 v63, 0xffff0000, v31
    v_pk_add_f32 v[128:129], v[128:129], v[56:57]
    v_pk_add_f32 v[130:131], v[130:131], v[58:59]
    v_pk_add_f32 v[132:133], v[132:133], v[60:61]
    v_pk_add_f32 v[134:135], v[134:135], v[62:63]
    v_cvt_pk_bf16_f32 v68, v128, v129
    v_cvt_pk_bf16_f32 v69, v130, v131
    v_cvt_pk_bf16_f32 v70, v132, v133
    v_cvt_pk_bf16_f32 v71, v134, v135
    s_add_u32 s81, s80, 32768
    s_nop 0
    v_permlane16_swap_b32 v68, v70
    v_permlane16_swap_b32 v69, v71
    buffer_store_dwordx4 v[68:71], v10, s[28:31], s81 offen
    s_waitcnt vmcnt(3)
    v_lshlrev_b32 v56, 16, v32
    v_and_b32 v57, 0xffff0000, v32
    v_lshlrev_b32 v58, 16, v33
    v_and_b32 v59, 0xffff0000, v33
    v_lshlrev_b32 v60, 16, v34
    v_and_b32 v61, 0xffff0000, v34
    v_lshlrev_b32 v62, 16, v35
    v_and_b32 v63, 0xffff0000, v35
    v_pk_add_f32 v[144:145], v[144:145], v[56:57]
    v_pk_add_f32 v[146:147], v[146:147], v[58:59]
    v_pk_add_f32 v[148:149], v[148:149], v[60:61]
    v_pk_add_f32 v[150:151], v[150:151], v[62:63]
    v_cvt_pk_bf16_f32 v72, v144, v145
    v_cvt_pk_bf16_f32 v73, v146, v147
    v_cvt_pk_bf16_f32 v74, v148, v149
    v_cvt_pk_bf16_f32 v75, v150, v151
    s_add_u32 s81, s80, 65536
    s_nop 0
    v_permlane16_swap_b32 v72, v74
    v_permlane16_swap_b32 v73, v75
    buffer_store_dwordx4 v[72:75], v10, s[28:31], s81 offen
    s_waitcnt vmcnt(3)
    v_lshlrev_b32 v56, 16, v36
    v_and_b32 v57, 0xffff0000, v36
    v_lshlrev_b32 v58, 16, v37
    v_and_b32 v59, 0xffff0000, v37
    v_lshlrev_b32 v60, 16, v38
    v_and_b32 v61, 0xffff0000, v38
    v_lshlrev_b32 v62, 16, v39
    v_and_b32 v63, 0xffff0000, v39
    v_pk_add_f32 v[160:161], v[160:161], v[56:57]
    v_pk_add_f32 v[162:163], v[162:163], v[58:59]
    v_pk_add_f32 v[164:165], v[164:165], v[60:61]
    v_pk_add_f32 v[166:167], v[166:167], v[62:63]
    v_cvt_pk_bf16_f32 v76, v160, v161
    v_cvt_pk_bf16_f32 v77, v162, v163
    v_cvt_pk_bf16_f32 v78, v164, v165
    v_cvt_pk_bf16_f32 v79, v166, v167
    s_add_u32 s81, s80, 98304
    s_nop 0
    v_permlane16_swap_b32 v76, v78
    v_permlane16_swap_b32 v77, v79
    buffer_store_dwordx4 v[76:79], v10, s[28:31], s81 offen
    s_endpgm
L_prod:
    s_lshl_b32 s57, s27, 12
    s_lshl_b32 s58, s27, 11
    s_lshl_b32 s59, s27, 10
    v_lshrrev_b32 v20, 3, v0
    v_lshlrev_b32 v20, 11, v20
    v_lshrrev_b32 v21, 4, v0
    v_and_b32 v22, 7, v0
    v_xor_b32 v21, v21, v22
    v_lshlrev_b32 v21, 4, v21
    v_add_u32 v20, v20, v21
    s_lshl_b32 s53, s44, 18
    s_lshl_b32 s54, s27, 16
    s_add_u32 s54, s54, s53
    v_add_u32 v6, s54, v20
    v_xor_b32 v21, 64, v20
    v_add_u32 v7, s54, v21
    v_add_u32 v7, 0x4000, v7
    v_add_u32 v8, 0x8000, v6
    v_add_u32 v9, 0x8000, v7
    s_max_u32 s53, s53, 0x8000
    s_sub_u32 s53, s53, 0x8000
    s_lshl_b32 s54, s27, 14
    s_add_u32 s53, s53, s54
    s_lshl_b32 s54, s27, 6
    s_and_b32 s54, s54, 64
    v_xor_b32 v18, s54, v20
    v_add_u32 v18, s53, v18
    s_lshl_b32 s55, s45, 7
    s_mul_i32 s53, s27, 98304
    s_add_u32 s55, s55, s53
    v_lshrrev_b32 v20, 3, v0
    v_mul_u32_u24 v20, 6144, v20
    v_bfe_u32 v21, v0, 4, 1
    v_lshlrev_b32 v21, 1, v21
    v_xor_b32 v21, v21, v22
    v_lshlrev_b32 v21, 4, v21
    v_add_u32 v12, v20, v21
    v_add_u32 v12, s55, v12
    v_xor_b32 v21, 64, v21
    v_add_u32 v13, v20, v21
    v_add_u32 v13, s55, v13
    v_add_u32 v13, 49152, v13
    v_add_u32 v14, 2048, v12
    v_add_u32 v15, 2048, v13
    v_add_u32 v16, 4096, v12
    v_add_u32 v17, 4096, v13
    s_lshr_b32 s53, s44, 3
    s_lshl_b32 s65, s53, 3
    s_and_b32 s54, s45, 12
    s_add_u32 s65, s65, s54
    s_and_b32 s65, s65, 15
    s_mov_b32 s100, 0x86534210
    s_mov_b32 s101, 0xfedbca97
    s_cmp_eq_u32 s47, 1
    s_cselect_b32 s100, 0x76453201, s100
    s_cselect_b32 s101, 0xfecdba89, s101
    s_cmp_eq_u32 s47, 2
    s_cselect_b32 s100, 0x75643120, s100
    s_cselect_b32 s101, 0xfdecb9a8, s101
    s_cmp_eq_u32 s47, 3
    s_cselect_b32 s100, 0x67542310, s100
    s_cselect_b32 s101, 0xefdcab98, s101
    s_waitcnt lgkmcnt(0)
    s_add_u32 s96, s24, 50331648
    s_addc_u32 s97, s25, 0
    s_mov_b32 s98, 1048576
    s_mov_b32 s99, 0x20000
    s_mov_b32 s28, s4
    s_mov_b32 s29, s5
    s_mov_b32 s30, 4194304
    s_mov_b32 s31, 0x20000
    s_mov_b32 s32, s6
    s_mov_b32 s33, s7
    s_mov_b32 s34, 6291456
    s_mov_b32 s35, 0x20000
    s_mov_b32 s48, 0
    s_mov_b32 s51, 0
    s_lshl_b32 s53, s48, 2
    s_lshr_b64 s[54:55], s[100:101], s53
    s_add_u32 s53, s54, s65
    s_and_b32 s53, s53, 15
    s_mul_i32 s49, s53, 128
    s_mul_i32 s50, s53, 393216
    s_add_u32 s56, s51, s57
    s_add_u32 m0, s56, 2048
    s_nop 0
    buffer_load_dwordx4 v6, s[28:31], s49 offen lds
    s_add_u32 m0, s56, 3072
    s_nop 0
    buffer_load_dwordx4 v7, s[28:31], s49 offen lds
    s_add_u32 m0, s56, 4096
    s_nop 0
    buffer_load_dwordx4 v8, s[28:31], s49 offen lds
    s_add_u32 m0, s56, 5120
    s_nop 0
    buffer_load_dwordx4 v9, s[28:31], s49 offen lds
    s_cmp_ge_u32 s27, 2
    s_cbranch_scc1 skip_12
    s_add_u32 s56, s51, s59
    s_add_u32 m0, s56, 0
    s_nop 0
    buffer_load_dwordx4 v18, s[28:31], s49 offen lds
skip_12:
    s_add_u32 s56, s51, s58
    s_add_u32 m0, s56, 18432
    s_nop 0
    buffer_load_dwordx4 v12, s[32:35], s50 offen lds
    s_add_u32 m0, s56, 19456
    s_nop 0
    buffer_load_dwordx4 v13, s[32:35], s50 offen lds
    s_add_u32 m0, s56, 26624
    s_nop 0
    buffer_load_dwordx4 v14, s[32:35], s50 offen lds
    s_add_u32 m0, s56, 27648
    s_nop 0
    buffer_load_dwordx4 v15, s[32:35], s50 offen lds
    s_add_u32 m0, s56, 34816
    s_nop 0
    buffer_load_dwordx4 v16, s[32:35], s50 offen lds
    s_add_u32 m0, s56, 35840
    s_nop 0
    buffer_load_dwordx4 v17, s[32:35], s50 offen lds
    s_add_u32 s51, s51, 43008
    s_cmp_ge_u32 s51, 129024
    s_cselect_b32 s51, 0, s51
    s_add_u32 s48, s48, 1
    s_load_dword s62, s[96:97], 0
    s_getpc_b64 s[78:79]
pc_14:
    s_sub_u32 s78, s78, pc_14-KSTART-60
    s_subb_u32 s79, s79, 0
    s_lshr_b32 s53, s2, 3
    s_lshl_b32 s53, s53, 2
    s_add_u32 s53, s53, s27
    s_lshl_b32 s53, s53, 7
    s_add_u32 s54, s53, 0
    s_min_u32 s54, s54, KEND-KSTART-68
    s_load_dwordx2 s[66:67], s[78:79], s54
    s_add_u32 s54, s53, 16384
    s_min_u32 s54, s54, KEND-KSTART-68
    s_load_dwordx2 s[66:67], s[78:79], s54
    s_add_u32 s54, s53, 32768
    s_min_u32 s54, s54, KEND-KSTART-68
    s_load_dwordx2 s[66:67], s[78:79], s54
ct_13:
    s_lshl_b32 s53, s2, 2
    s_add_u32 s53, s53, s27
    s_lshl_b32 s54, s53, 7
    s_add_u32 s54, s54, 65536
    s_and_b32 s53, s53, 0x3ff
    s_lshl_b32 s53, s53, 6
    s_load_dword s66, s[96:97], s53
    s_load_dword s66, s[96:97], s54
    v_mov_b32 v28, 160256
    v_mov_b32 v32, 0
    v_mov_b32 v33, 0
    v_mov_b32 v34, 0
    v_mov_b32 v35, 0
    ds_write_b128 v28, v[32:35]
    ds_write_b128 v28, v[32:35] offset:16
    v_lshlrev_b32 v30, 2, v0
    s_and_b32 s81, s44, 7
    s_lshl_b32 s74, s2, 2
    s_add_u32 s74, s74, s27
    s_mul_i32 s74, s74, 448
    s_mov_b32 s75, 3670016
    v_lshrrev_b32 v20, 4, v0
    v_lshlrev_b32 v21, 10, v20
    v_bfe_u32 v22, v0, 2, 2
    v_lshlrev_b32 v22, 7, v22
    v_add_u32 v21, v21, v22
    v_and_b32 v22, 3, v0
    v_lshlrev_b32 v22, 3, v22
    v_add_u32 v21, v21, v22
    v_bfe_u32 v22, v0, 3, 2
    v_xor_b32 v22, s27, v22
    v_lshlrev_b32 v22, 5, v22
    v_add_u32 v40, v21, v22
    v_add_u32 v40, 18432, v40
    s_mov_b32 s69, 0
    s_mov_b64 s[54:55], s[100:101]
ds_15:
    s_and_b32 s53, s54, 15
    s_cmp_eq_u32 s53, s81
    s_cbranch_scc1 dk_16
    s_lshr_b64 s[54:55], s[54:55], 4
    s_add_u32 s69, s69, 1
    s_cmp_lt_u32 s69, 15
    s_cbranch_scc1 ds_15
dk_16:
    s_mul_i32 s53, s69, 43
    s_lshr_b32 s53, s53, 7
    s_mul_i32 s53, s53, 3
    s_sub_u32 s53, s69, s53
    s_mul_i32 s53, s53, 43008
    v_add_u32 v40, s53, v40
    s_add_u32 s69, s69, 2
    s_add_u32 s80, s81, s65
    s_and_b32 s80, s80, 15
    v_mov_b32 v44, 0x3f803f80
    v_mov_b32 v45, 0x3f803f80
    v_mov_b32 v46, 0x3f803f80
    v_mov_b32 v47, 0x3f803f80
    v_lshlrev_b32 v41, 12, v20
    v_and_b32 v22, 15, v0
    v_lshl_add_u32 v41, v22, 2, v41
    v_cmp_eq_u32 s[86:87], 1, v20
    v_cmp_eq_u32 s[88:89], 2, v20
    v_lshlrev_b32 v22, 4, v22
    v_mul_u32_u24 v42, 12288, v20
    v_add_u32 v42, v42, v22
    v_bfe_u32 v23, v0, 4, 1
    v_lshrrev_b32 v24, 5, v0
    v_lshl_add_u32 v23, v24, 1, v23
    v_lshl_add_u32 v43, v23, 2, v22
    s_lshl_b32 s53, s27, 8
    s_add_u32 s53, s53, 153600
    v_add_u32 v43, s53, v43
    s_lshl_b32 s53, s44, 7
    s_sub_u32 s53, s53, 16
    v_add_u32 v22, s53, v0
    v_add_u32 v23, 16, v22
    v_cmp_gt_i32 vcc, 0, v22
    v_add_u32 v24, 128, v0
    v_min_u32 v24, 143, v24
    v_cndmask_b32 v23, v22, v23, vcc
    v_lshlrev_b32 v49, 3, v23
    v_add_u32 v22, 64, v22
    v_lshlrev_b32 v50, 3, v22
    v_add_u32 v22, s53, v24
    v_lshlrev_b32 v51, 3, v22
    v_mov_b32 v22, 153600
    v_lshl_add_u32 v52, v0, 2, v22
    v_lshl_add_u32 v53, v0, 3, v22
    v_lshl_add_u32 v54, v24, 3, v22
    v_lshl_add_u32 v55, v24, 2, v22
    s_mul_i32 s84, s80, 12288
    s_lshl_b32 s91, s45, 8
    s_add_u32 s84, s84, s91
    s_lshl_b32 s53, s27, 6
    s_add_u32 s84, s84, s53
    s_add_u32 s90, s91, 28672
    s_lshl_b32 s82, s80, 4
    s_lshl_b32 s53, s27, 2
    s_add_u32 s82, s82, s53
    s_add_u32 s82, s82, s90
    s_add_u32 s91, s91, s57
    s_add_u32 s40, s24, 32505856
    s_addc_u32 s41, s25, 0
    s_mov_b32 s42, 1048576
    s_mov_b32 s43, 0x20000
    s_add_u32 s36, s24, 31457280
    s_addc_u32 s37, s25, 0
    s_mov_b32 s38, 16384
    s_mov_b32 s39, 0x20000
    s_lshl_b32 s53, s48, 2
    s_lshr_b64 s[54:55], s[100:101], s53
    s_add_u32 s53, s54, s65
    s_and_b32 s53, s53, 15
    s_mul_i32 s49, s53, 128
    s_mul_i32 s50, s53, 393216
    s_add_u32 s56, s51, s57
    s_add_u32 m0, s56, 2048
    s_nop 0
    buffer_load_dwordx4 v6, s[28:31], s49 offen lds
    s_add_u32 m0, s56, 3072
    s_nop 0
    buffer_load_dwordx4 v7, s[28:31], s49 offen lds
    s_add_u32 m0, s56, 4096
    s_nop 0
    buffer_load_dwordx4 v8, s[28:31], s49 offen lds
    s_add_u32 m0, s56, 5120
    s_nop 0
    buffer_load_dwordx4 v9, s[28:31], s49 offen lds
    s_cmp_ge_u32 s27, 2
    s_cbranch_scc1 skip_17
    s_add_u32 s56, s51, s59
    s_add_u32 m0, s56, 0
    s_nop 0
    buffer_load_dwordx4 v18, s[28:31], s49 offen lds
skip_17:
    s_add_u32 s56, s51, s58
    s_add_u32 m0, s56, 18432
    s_nop 0
    buffer_load_dwordx4 v12, s[32:35], s50 offen lds
    s_add_u32 m0, s56, 19456
    s_nop 0
    buffer_load_dwordx4 v13, s[32:35], s50 offen lds
    s_add_u32 m0, s56, 26624
    s_nop 0
    buffer_load_dwordx4 v14, s[32:35], s50 offen lds
    s_add_u32 m0, s56, 27648
    s_nop 0
    buffer_load_dwordx4 v15, s[32:35], s50 offen lds
    s_add_u32 m0, s56, 34816
    s_nop 0
    buffer_load_dwordx4 v16, s[32:35], s50 offen lds
    s_add_u32 m0, s56, 35840
    s_nop 0
    buffer_load_dwordx4 v17, s[32:35], s50 offen lds
    s_add_u32 s51, s51, 43008
    s_cmp_ge_u32 s51, 129024
    s_cselect_b32 s51, 0, s51
    s_add_u32 s48, s48, 1
    s_waitcnt vmcnt(10)
    s_barrier
    s_lshl_b32 s53, s48, 2
    s_lshr_b64 s[54:55], s[100:101], s53
    s_add_u32 s53, s54, s65
    s_and_b32 s53, s53, 15
    s_mul_i32 s49, s53, 128
    s_mul_i32 s50, s53, 393216
    s_add_u32 s56, s51, s57
    s_add_u32 m0, s56, 2048
    s_nop 0
    buffer_load_dwordx4 v6, s[28:31], s49 offen lds
    s_add_u32 m0, s56, 3072
    s_nop 0
    buffer_load_dwordx4 v7, s[28:31], s49 offen lds
    s_add_u32 m0, s56, 4096
    s_nop 0
    buffer_load_dwordx4 v8, s[28:31], s49 offen lds
    s_add_u32 m0, s56, 5120
    s_nop 0
    buffer_load_dwordx4 v9, s[28:31], s49 offen lds
    s_cmp_ge_u32 s27, 2
    s_cbranch_scc1 skip_18
    s_add_u32 s56, s51, s59
    s_add_u32 m0, s56, 0
    s_nop 0
    buffer_load_dwordx4 v18, s[28:31], s49 offen lds
skip_18:
    s_add_u32 s56, s51, s58
    s_add_u32 m0, s56, 18432
    s_nop 0
    buffer_load_dwordx4 v12, s[32:35], s50 offen lds
    s_add_u32 m0, s56, 19456
    s_nop 0
    buffer_load_dwordx4 v13, s[32:35], s50 offen lds
    s_add_u32 m0, s56, 26624
    s_nop 0
    buffer_load_dwordx4 v14, s[32:35], s50 offen lds
    s_add_u32 m0, s56, 27648
    s_nop 0
    buffer_load_dwordx4 v15, s[32:35], s50 offen lds
    s_add_u32 m0, s56, 34816
    s_nop 0
    buffer_load_dwordx4 v16, s[32:35], s50 offen lds
    s_add_u32 m0, s56, 35840
    s_nop 0
    buffer_load_dwordx4 v17, s[32:35], s50 offen lds
    s_add_u32 s51, s51, 43008
    s_cmp_ge_u32 s51, 129024
    s_cselect_b32 s51, 0, s51
    s_cmp_lg_u32 s48, s69
    s_cbranch_scc1 nd1_19
    ds_read_b64_tr_b16 v[56:57], v40 offset:0
    ds_read_b64_tr_b16 v[58:59], v40 offset:512
    ds_read_b64_tr_b16 v[60:61], v40 offset:4096
    ds_read_b64_tr_b16 v[62:63], v40 offset:4608
    ds_read_b64_tr_b16 v[64:65], v40 offset:8192
    ds_read_b64_tr_b16 v[66:67], v40 offset:8704
    ds_read_b64_tr_b16 v[68:69], v40 offset:12288
    ds_read_b64_tr_b16 v[70:71], v40 offset:12800
    ds_read_b64_tr_b16 v[72:73], v40 offset:16384
    ds_read_b64_tr_b16 v[74:75], v40 offset:16896
    ds_read_b64_tr_b16 v[76:77], v40 offset:20480
    ds_read_b64_tr_b16 v[78:79], v40 offset:20992
    s_waitcnt lgkmcnt(0)
    s_add_u32 s62, s62, 1
    v_mfma_f32_16x16x32_bf16 v[80:83], v[44:47], v[56:59], 0
    v_mfma_f32_16x16x32_bf16 v[84:87], v[44:47], v[64:67], 0
    v_mfma_f32_16x16x32_bf16 v[88:91], v[44:47], v[72:75], 0
    v_mfma_f32_16x16x32_bf16 v[80:83], v[44:47], v[60:63], v[80:83]
    v_mfma_f32_16x16x32_bf16 v[84:87], v[44:47], v[68:71], v[84:87]
    v_mfma_f32_16x16x32_bf16 v[88:91], v[44:47], v[76:79], v[88:91]
    s_nop 7
    v_cndmask_b32 v80, v80, v84, s[86:87]
    v_cndmask_b32 v80, v80, v88, s[88:89]
    s_mov_b32 exec_hi, 0xffff
    buffer_store_dword v80, v41, s[40:43], s84 offen sc1
    s_mov_b64 exec, -1
    s_branch nd2_20
nd1_19:
    s_add_u32 s53, s69, 1
    s_cmp_lg_u32 s48, s53
    s_cbranch_scc1 nd2_20
    s_waitcnt vmcnt(10)
    v_mov_b32 v28, 0
    v_mov_b32 v29, s62
    s_mov_b64 exec, 1
    buffer_store_dword v29, v28, s[96:99], s82 offen sc1
    s_mov_b64 exec, -1
noflag_21:
nd2_20:
    s_add_u32 s48, s48, 1
    s_lshl_b32 s53, s48, 2
    s_lshr_b64 s[54:55], s[100:101], s53
    s_add_u32 s53, s54, s65
    s_and_b32 s53, s53, 15
    s_mul_i32 s49, s53, 128
    s_mul_i32 s50, s53, 393216
    s_add_u32 s47, s51, s57
    s_add_u32 m0, s47, 2048
ploop_22:
    s_waitcnt vmcnt(10)
    s_barrier
    buffer_load_dwordx4 v6, s[28:31], s49 offen lds
    s_add_u32 m0, s47, 3072
    s_add_u32 s52, s48, 1
    buffer_load_dwordx4 v7, s[28:31], s49 offen lds
    s_add_u32 m0, s47, 4096
    s_lshl_b32 s53, s52, 2
    buffer_load_dwordx4 v8, s[28:31], s49 offen lds
    s_add_u32 m0, s47, 5120
    s_lshr_b64 s[54:55], s[100:101], s53
    buffer_load_dwordx4 v9, s[28:31], s49 offen lds
    s_cmp_ge_u32 s27, 2
    s_cbranch_scc1 skip_23
    s_add_u32 s47, s51, s59
    s_add_u32 m0, s47, 0
    s_nop 0
    buffer_load_dwordx4 v18, s[28:31], s49 offen lds
skip_23:
    s_add_u32 s47, s51, s58
    s_add_u32 m0, s47, 18432
    s_add_u32 s53, s54, s65
    buffer_load_dwordx4 v12, s[32:35], s50 offen lds
    s_add_u32 m0, s47, 19456
    s_and_b32 s53, s53, 15
    buffer_load_dwordx4 v13, s[32:35], s50 offen lds
    s_add_u32 m0, s47, 26624
    s_mul_i32 s3, s53, 128
    buffer_load_dwordx4 v14, s[32:35], s50 offen lds
    s_add_u32 m0, s47, 27648
    s_mul_i32 s64, s53, 393216
    buffer_load_dwordx4 v15, s[32:35], s50 offen lds
    s_add_u32 m0, s47, 34816
    s_nop 0
    buffer_load_dwordx4 v16, s[32:35], s50 offen lds
    s_add_u32 m0, s47, 35840
    s_nop 0
    buffer_load_dwordx4 v17, s[32:35], s50 offen lds
    s_cmp_lg_u32 s48, s69
    s_cbranch_scc1 nd1_24
    ds_read_b64_tr_b16 v[56:57], v40 offset:0
    ds_read_b64_tr_b16 v[58:59], v40 offset:512
    ds_read_b64_tr_b16 v[60:61], v40 offset:4096
    ds_read_b64_tr_b16 v[62:63], v40 offset:4608
    ds_read_b64_tr_b16 v[64:65], v40 offset:8192
    ds_read_b64_tr_b16 v[66:67], v40 offset:8704
    ds_read_b64_tr_b16 v[68:69], v40 offset:12288
    ds_read_b64_tr_b16 v[70:71], v40 offset:12800
    ds_read_b64_tr_b16 v[72:73], v40 offset:16384
    ds_read_b64_tr_b16 v[74:75], v40 offset:16896
    ds_read_b64_tr_b16 v[76:77], v40 offset:20480
    ds_read_b64_tr_b16 v[78:79], v40 offset:20992
    s_waitcnt lgkmcnt(0)
    s_add_u32 s62, s62, 1
    v_mfma_f32_16x16x32_bf16 v[80:83], v[44:47], v[56:59], 0
    v_mfma_f32_16x16x32_bf16 v[84:87], v[44:47], v[64:67], 0
    v_mfma_f32_16x16x32_bf16 v[88:91], v[44:47], v[72:75], 0
    v_mfma_f32_16x16x32_bf16 v[80:83], v[44:47], v[60:63], v[80:83]
    v_mfma_f32_16x16x32_bf16 v[84:87], v[44:47], v[68:71], v[84:87]
    v_mfma_f32_16x16x32_bf16 v[88:91], v[44:47], v[76:79], v[88:91]
    s_nop 7
    v_cndmask_b32 v80, v80, v84, s[86:87]
    v_cndmask_b32 v80, v80, v88, s[88:89]
    s_mov_b32 exec_hi, 0xffff
    buffer_store_dword v80, v41, s[40:43], s84 offen sc1
    s_mov_b64 exec, -1
    s_branch nd2_25
nd1_24:
    s_add_u32 s53, s69, 1
    s_cmp_lg_u32 s48, s53
    s_cbranch_scc1 nd2_25
    s_waitcnt vmcnt(10)
    v_mov_b32 v28, 0
    v_mov_b32 v29, s62
    s_mov_b64 exec, 1
    buffer_store_dword v29, v28, s[96:99], s82 offen sc1
    s_mov_b64 exec, -1
noflag_26:
nd2_25:
    s_cmp_lg_u32 s48, 14
    s_cbranch_scc1 ct_27
    s_getpc_b64 s[78:79]
pc_28:
    s_sub_u32 s78, s78, pc_28-KSTART-60
    s_subb_u32 s79, s79, 0
    s_lshr_b32 s53, s2, 3
    s_lshl_b32 s53, s53, 2
    s_add_u32 s53, s53, s27
    s_lshl_b32 s53, s53, 7
    s_add_u32 s54, s53, 0
    s_min_u32 s54, s54, KEND-KSTART-68
    s_load_dwordx2 s[66:67], s[78:79], s54
    s_add_u32 s54, s53, 16384
    s_min_u32 s54, s54, KEND-KSTART-68
    s_load_dwordx2 s[66:67], s[78:79], s54
    s_add_u32 s54, s53, 32768
    s_min_u32 s54, s54, KEND-KSTART-68
    s_load_dwordx2 s[66:67], s[78:79], s54
ct_27:
    s_bitcmp1_b32 0x3ff0, s48
    s_cbranch_scc0 lp_29
    s_getreg_b32 s53, hwreg(HW_REG_IB_STS, 8, 4)
    s_cmp_gt_u32 s53, 8
    s_cbranch_scc1 lp_29
    s_cmp_ge_u32 s74, 7340032
    s_cbranch_scc1 lp_29
    s_add_u32 s53, s48, 1
    s_cmp_eq_u32 s53, s69
    s_cbranch_scc1 lp_29
    s_add_u32 s78, s12, s74
    s_addc_u32 s79, s13, 0
    s_load_dwordx2 s[66:67], s[78:79], 60
    s_load_dwordx2 s[66:67], s[78:79], 188
    s_load_dwordx2 s[66:67], s[78:79], 316
    s_load_dword s66, s[78:79], 384
    s_add_u32 s74, s74, s75
    s_sub_u32 s75, 458752, s75
lp_29:
    s_add_u32 s51, s51, 43008
    s_cmp_ge_u32 s51, 129024
    s_cselect_b32 s51, 0, s51
    s_mov_b32 s49, s3
    s_mov_b32 s50, s64
    s_mov_b32 s48, s52
    s_add_u32 s47, s51, s57
    s_add_u32 m0, s47, 2048
    s_cmp_lt_u32 s48, 12
    s_cbranch_scc1 ploop_22
    s_lshl_b32 s53, s48, 2
    s_lshr_b64 s[54:55], s[100:101], s53
    s_add_u32 s53, s54, s65
    s_and_b32 s53, s53, 15
    s_mul_i32 s49, s53, 128
    s_mul_i32 s50, s53, 393216
    s_add_u32 s47, s51, s57
    s_add_u32 m0, s47, 2048
ploop_30:
    s_waitcnt vmcnt(10)
    s_barrier
    buffer_load_dwordx4 v6, s[28:31], s49 offen lds
    s_add_u32 m0, s47, 3072
    s_add_u32 s52, s48, 1
    buffer_load_dwordx4 v7, s[28:31], s49 offen lds
    s_add_u32 m0, s47, 4096
    s_lshl_b32 s53, s52, 2
    buffer_load_dwordx4 v8, s[28:31], s49 offen lds
    s_add_u32 m0, s47, 5120
    s_lshr_b64 s[54:55], s[100:101], s53
    buffer_load_dwordx4 v9, s[28:31], s49 offen lds
    s_cmp_ge_u32 s27, 2
    s_cbranch_scc1 skip_31
    s_add_u32 s47, s51, s59
    s_add_u32 m0, s47, 0
    s_nop 0
    buffer_load_dwordx4 v18, s[28:31], s49 offen lds
skip_31:
    s_add_u32 s47, s51, s58
    s_add_u32 m0, s47, 18432
    s_add_u32 s53, s54, s65
    buffer_load_dwordx4 v12, s[32:35], s50 offen lds
    s_add_u32 m0, s47, 19456
    s_and_b32 s53, s53, 15
    buffer_load_dwordx4 v13, s[32:35], s50 offen lds
    s_add_u32 m0, s47, 26624
    s_mul_i32 s3, s53, 128
    buffer_load_dwordx4 v14, s[32:35], s50 offen lds
    s_add_u32 m0, s47, 27648
    s_mul_i32 s64, s53, 393216
    buffer_load_dwordx4 v15, s[32:35], s50 offen lds
    s_add_u32 m0, s47, 34816
    s_nop 0
    buffer_load_dwordx4 v16, s[32:35], s50 offen lds
    s_add_u32 m0, s47, 35840
    s_nop 0
    buffer_load_dwordx4 v17, s[32:35], s50 offen lds
    s_cmp_lg_u32 s48, 14
    s_cbranch_scc1 ct_32
    s_getpc_b64 s[78:79]
pc_33:
    s_sub_u32 s78, s78, pc_33-KSTART-60
    s_subb_u32 s79, s79, 0
    s_lshr_b32 s53, s2, 3
    s_lshl_b32 s53, s53, 2
    s_add_u32 s53, s53, s27
    s_lshl_b32 s53, s53, 7
    s_add_u32 s54, s53, 0
    s_min_u32 s54, s54, KEND-KSTART-68
    s_load_dwordx2 s[66:67], s[78:79], s54
    s_add_u32 s54, s53, 16384
    s_min_u32 s54, s54, KEND-KSTART-68
    s_load_dwordx2 s[66:67], s[78:79], s54
    s_add_u32 s54, s53, 32768
    s_min_u32 s54, s54, KEND-KSTART-68
    s_load_dwordx2 s[66:67], s[78:79], s54
ct_32:
    s_bitcmp1_b32 0x3ff0, s48
    s_cbranch_scc0 lp_34
    s_getreg_b32 s53, hwreg(HW_REG_IB_STS, 8, 4)
    s_cmp_gt_u32 s53, 8
    s_cbranch_scc1 lp_34
    s_cmp_ge_u32 s74, 7340032
    s_cbranch_scc1 lp_34
    s_add_u32 s78, s12, s74
    s_addc_u32 s79, s13, 0
    s_load_dwordx2 s[66:67], s[78:79], 60
    s_load_dwordx2 s[66:67], s[78:79], 188
    s_load_dwordx2 s[66:67], s[78:79], 316
    s_load_dword s66, s[78:79], 384
    s_add_u32 s74, s74, s75
    s_sub_u32 s75, 458752, s75
lp_34:
    s_add_u32 s51, s51, 43008
    s_cmp_ge_u32 s51, 129024
    s_cselect_b32 s51, 0, s51
    s_mov_b32 s49, s3
    s_mov_b32 s50, s64
    s_mov_b32 s48, s52
    s_add_u32 s47, s51, s57
    s_add_u32 m0, s47, 2048
    s_cmp_lt_u32 s48, 16
    s_cbranch_scc1 ploop_30
    s_waitcnt vmcnt(10)
    s_barrier
    s_cmp_eq_u32 s27, 3
    s_cbranch_scc1 rows_35
    buffer_load_dword v48, v30, s[96:99], s90 offen sc1
    s_add_u32 s54, s91, 0
    buffer_load_dwordx4 v[56:59], v42, s[40:43], s54 offen sc1
    s_add_u32 s54, s91, 49152
    buffer_load_dwordx4 v[60:63], v42, s[40:43], s54 offen sc1
    s_add_u32 s54, s91, 98304
    buffer_load_dwordx4 v[64:67], v42, s[40:43], s54 offen sc1
    s_add_u32 s54, s91, 147456
    buffer_load_dwordx4 v[68:71], v42, s[40:43], s54 offen sc1
    s_branch gend_36
rows_35:
    buffer_load_dwordx2 v[56:57], v49, s[36:39], 0 offen sc1
    buffer_load_dwordx2 v[58:59], v50, s[36:39], 0 offen sc1
    buffer_load_dwordx2 v[60:61], v51, s[36:39], 0 offen sc1
gend_36:
    s_waitcnt vmcnt(3)
    s_barrier
    s_waitcnt vmcnt(0)
    s_mov_b32 s83, 0
gchk_37:
    s_cmp_eq_u32 s27, 3
    s_cbranch_scc1 grows_38
    v_cmp_ne_u32 vcc, s62, v48
    s_cbranch_vccnz gretry_40
    v_pk_add_f32 v[56:57], v[56:57], v[60:61]
    v_pk_add_f32 v[64:65], v[64:65], v[68:69]
    v_pk_add_f32 v[58:59], v[58:59], v[62:63]
    v_pk_add_f32 v[66:67], v[66:67], v[70:71]
    v_pk_add_f32 v[56:57], v[56:57], v[64:65]
    v_pk_add_f32 v[58:59], v[58:59], v[66:67]
    s_nop 1
    v_permlane32_swap_b32 v56, v58
    v_permlane32_swap_b32 v57, v59
    v_add_f32 v56, v56, v58
    v_add_f32 v57, v57, v59
    s_nop 1
    v_permlane16_swap_b32 v56, v57
    v_add_f32 v56, v56, v57
    ds_write_b32 v43, v56
    s_branch gdone_39
gretry_40:
    s_add_u32 s83, s83, 1
    s_cmp_gt_u32 s83, 0x8000
    s_cbranch_scc1 gdone_39
    s_cmp_eq_u32 s27, 3
    s_cbranch_scc1 rows_41
    buffer_load_dword v48, v30, s[96:99], s90 offen sc1
    s_add_u32 s54, s91, 0
    buffer_load_dwordx4 v[56:59], v42, s[40:43], s54 offen sc1
    s_add_u32 s54, s91, 49152
    buffer_load_dwordx4 v[60:63], v42, s[40:43], s54 offen sc1
    s_add_u32 s54, s91, 98304
    buffer_load_dwordx4 v[64:67], v42, s[40:43], s54 offen sc1
    s_add_u32 s54, s91, 147456
    buffer_load_dwordx4 v[68:71], v42, s[40:43], s54 offen sc1
    s_branch gend_42
rows_41:
    buffer_load_dwordx2 v[56:57], v49, s[36:39], 0 offen sc1
    buffer_load_dwordx2 v[58:59], v50, s[36:39], 0 offen sc1
    buffer_load_dwordx2 v[60:61], v51, s[36:39], 0 offen sc1
gend_42:
    s_waitcnt vmcnt(0)
    s_branch gchk_37
grows_38:
    v_cmp_ne_u32 vcc, s62, v57
    s_cbranch_vccnz gretry_40
    v_cmp_ne_u32 vcc, s62, v59
    s_cbranch_vccnz gretry_40
    v_cmp_ne_u32 vcc, s62, v61
    s_cbranch_vccnz gretry_40
    v_and_b32 v64, 0xffff0000, v56
    v_and_b32 v66, 0xffff0000, v58
    v_and_b32 v68, 0xffff0000, v60
    v_rcp_f32 v64, v64
    v_rcp_f32 v66, v66
    v_rcp_f32 v68, v68
    v_lshlrev_b32 v65, 16, v56
    v_lshlrev_b32 v67, 16, v58
    v_lshlrev_b32 v69, 16, v60
    ds_write_b64 v53, v[64:65] offset:768
    ds_write_b64 v53, v[66:67] offset:1280
    ds_write_b64 v54, v[68:69] offset:768
    ds_write_b32 v52, v65 offset:1920
    ds_write_b32 v52, v67 offset:2176
    ds_write_b32 v55, v69 offset:1920
    ds_write_b32 v52, v64 offset:2496
    ds_write_b32 v52, v66 offset:2752
    ds_write_b32 v55, v68 offset:2496
gdone_39:
    s_waitcnt lgkmcnt(0)
    s_barrier
    s_and_b32 s53, s2, 3
    s_lshl_b32 s53, s53, 2
    s_lshr_b32 s54, s2, 3
    s_and_b32 s55, s54, 3
    s_add_u32 s44, s53, s55
    s_bfe_u32 s53, s2, 0x10002
    s_lshl_b32 s53, s53, 3
    s_lshr_b32 s54, s2, 5
    s_add_u32 s45, s53, s54
    s_add_u32 s47, s44, s45
    s_and_b32 s47, s47, 3
    s_add_u32 s28, s24, 4194304
    s_addc_u32 s29, s25, 0
    s_mov_b32 s30, 4194304
    s_mov_b32 s31, 0x20000
    s_mov_b32 s32, s8
    s_mov_b32 s33, s9
    s_mov_b32 s34, 2097152
    s_mov_b32 s35, 0x20000
    s_lshl_b32 s57, s27, 12
    s_lshl_b32 s58, s27, 11
    s_lshl_b32 s53, s44, 3
    s_lshl_b32 s54, s27, 1
    s_add_u32 s54, s53, s54
    s_mul_i32 s54, s54, 32768
    v_lshlrev_b32 v10, 4, v0
    v_add_u32 v10, s54, v10
    v_add_u32 v11, 32768, v10
    s_lshl_b32 s55, s45, 7
    s_lshl_b32 s53, s27, 15
    s_add_u32 s55, s55, s53
    v_lshrrev_b32 v20, 3, v0
    v_bfe_u32 v21, v0, 4, 2
    v_lshlrev_b32 v21, 1, v21
    v_and_b32 v12, 7, v0
    v_xor_b32 v12, v12, v21
    v_lshlrev_b32 v12, 4, v12
    v_mul_u32_u24 v20, 2048, v20
    v_add_u32 v12, v12, v20
    v_add_u32 v12, s55, v12
    v_add_u32 v13, 16384, v12
    s_and_b32 s65, s44, 12
    s_mov_b32 s100, 0x86534210
    s_mov_b32 s101, 0xfedbca97
    s_cmp_eq_u32 s47, 1
    s_cselect_b32 s100, 0x76453201, s100
    s_cselect_b32 s101, 0xfecdba89, s101
    s_cmp_eq_u32 s47, 2
    s_cselect_b32 s100, 0x75643120, s100
    s_cselect_b32 s101, 0xfdecb9a8, s101
    s_cmp_eq_u32 s47, 3
    s_cselect_b32 s100, 0x67542310, s100
    s_cselect_b32 s101, 0xefdcab98, s101
    s_mov_b32 s48, 0
    s_mov_b32 s51, 0
    s_lshl_b32 s53, s48, 2
    s_lshr_b64 s[54:55], s[100:101], s53
    s_add_u32 s53, s54, s65
    s_and_b32 s53, s53, 15
    s_mul_i32 s49, s53, 2048
    s_mul_i32 s50, s53, 131072
    s_add_u32 s56, s51, s58
    s_add_u32 m0, s56, 16384
    s_waitcnt vmcnt(6)
    buffer_load_dwordx4 v12, s[32:35], s50 offen lds
    s_add_u32 m0, s56, 17408
    s_waitcnt vmcnt(6)
    buffer_load_dwordx4 v13, s[32:35], s50 offen lds
    s_mov_b32 s48, 1
    s_mov_b32 s51, 24576
    s_lshl_b32 s53, s48, 2
    s_lshr_b64 s[54:55], s[100:101], s53
    s_add_u32 s53, s54, s65
    s_and_b32 s53, s53, 15
    s_mul_i32 s49, s53, 2048
    s_mul_i32 s50, s53, 131072
    s_add_u32 s56, s51, s58
    s_add_u32 m0, s56, 16384
    s_waitcnt vmcnt(6)
    buffer_load_dwordx4 v12, s[32:35], s50 offen lds
    s_add_u32 m0, s56, 17408
    s_waitcnt vmcnt(6)
    buffer_load_dwordx4 v13, s[32:35], s50 offen lds
    s_mov_b32 s48, 2
    s_mov_b32 s51, 49152
    s_lshl_b32 s53, s48, 2
    s_lshr_b64 s[54:55], s[100:101], s53
    s_add_u32 s53, s54, s65
    s_and_b32 s53, s53, 15
    s_mul_i32 s49, s53, 2048
    s_mul_i32 s50, s53, 131072
    s_add_u32 s56, s51, s58
    s_add_u32 m0, s56, 16384
    s_waitcnt vmcnt(6)
    buffer_load_dwordx4 v12, s[32:35], s50 offen lds
    s_add_u32 m0, s56, 17408
    s_waitcnt vmcnt(6)
    buffer_load_dwordx4 v13, s[32:35], s50 offen lds
    s_mov_b32 s48, 3
    s_mov_b32 s51, 73728
    s_lshl_b32 s53, s48, 2
    s_lshr_b64 s[54:55], s[100:101], s53
    s_add_u32 s53, s54, s65
    s_and_b32 s53, s53, 15
    s_mul_i32 s49, s53, 2048
    s_mul_i32 s50, s53, 131072
    s_add_u32 s56, s51, s58
    s_add_u32 m0, s56, 16384
    s_waitcnt vmcnt(6)
    buffer_load_dwordx4 v12, s[32:35], s50 offen lds
    s_add_u32 m0, s56, 17408
    s_waitcnt vmcnt(6)
    buffer_load_dwordx4 v13, s[32:35], s50 offen lds
    s_mov_b32 s48, 4
    s_mov_b32 s51, 98304
    s_lshl_b32 s53, s48, 2
    s_lshr_b64 s[54:55], s[100:101], s53
    s_add_u32 s53, s54, s65
    s_and_b32 s53, s53, 15
    s_mul_i32 s49, s53, 2048
    s_mul_i32 s50, s53, 131072
    s_add_u32 s56, s51, s58
    s_add_u32 m0, s56, 16384
    s_waitcnt vmcnt(6)
    buffer_load_dwordx4 v12, s[32:35], s50 offen lds
    s_add_u32 m0, s56, 17408
    s_waitcnt vmcnt(6)
    buffer_load_dwordx4 v13, s[32:35], s50 offen lds
    s_mov_b32 s36, s4
    s_mov_b32 s37, s5
    s_mov_b32 s38, 4194304
    s_mov_b32 s39, 0x20000
    v_lshrrev_b32 v20, 3, v0
    v_lshlrev_b32 v20, 11, v20
    v_lshrrev_b32 v21, 4, v0
    v_and_b32 v22, 7, v0
    v_xor_b32 v21, v21, v22
    v_lshl_add_u32 v6, v21, 4, v20
    v_xor_b32 v7, 64, v6
    s_lshl_b32 s53, s44, 18
    s_lshl_b32 s54, s27, 16
    s_add_u32 s53, s53, s54
    s_lshl_b32 s54, s45, 7
    s_add_u32 s53, s53, s54
    s_add_u32 m0, s57, 122880
    s_add_u32 s54, s53, 0
    s_waitcnt vmcnt(6)
    buffer_load_dwordx4 v6, s[36:39], s54 offen lds
    s_add_u32 m0, s57, 123904
    s_add_u32 s54, s53, 16384
    s_waitcnt vmcnt(6)
    buffer_load_dwordx4 v7, s[36:39], s54 offen lds
    s_add_u32 m0, s57, 124928
    s_add_u32 s54, s53, 32768
    s_waitcnt vmcnt(6)
    buffer_load_dwordx4 v6, s[36:39], s54 offen lds
    s_add_u32 m0, s57, 125952
    s_add_u32 s54, s53, 49152
    s_waitcnt vmcnt(6)
    buffer_load_dwordx4 v7, s[36:39], s54 offen lds
    s_barrier
    s_lshl_b32 s63, s44, 7
    s_add_u32 s63, s63, 8192
    s_mov_b32 s77, 0
    s_mov_b32 s48, 0
    s_mov_b32 s51, 0
    s_lshl_b32 s53, s48, 2
    s_lshr_b64 s[54:55], s[100:101], s53
    s_add_u32 s53, s54, s65
    s_and_b32 s53, s53, 15
    s_lshl_b32 s68, 1, s53
    s_mul_i32 s49, s53, 2048
    s_mul_i32 s50, s53, 131072
    s_andn2_b32 s55, s68, s77
    s_cbranch_scc0 rdy_44
    s_mov_b32 exec_lo, 0xffff
    s_mov_b32 exec_hi, 0
    s_mov_b32 s56, 0
nd_43:
    buffer_load_dword v31, v30, s[96:99], s63 offen sc1
    s_add_u32 s56, s56, 1
    s_waitcnt vmcnt(0)
    v_cmp_eq_u32 vcc, s62, v31
    s_nop 1
    s_cmp_gt_u32 s56, 0x20000
    s_cselect_b32 s77, -1, vcc_lo
    s_andn2_b32 s55, s68, s77
    s_cbranch_scc1 nd_43
    s_mov_b64 exec, -1
rdy_44:
    s_add_u32 s56, s51, s57
    s_add_u32 m0, s56, 0
    s_nop 0
    buffer_load_dwordx4 v10, s[28:31], s49 offen sc1 lds
    buffer_load_dwordx4 v10, s[28:31], s49 offen offset:1024 sc1 lds
    s_add_u32 m0, s56, 2048
    s_nop 0
    buffer_load_dwordx4 v11, s[28:31], s49 offen sc1 lds
    buffer_load_dwordx4 v11, s[28:31], s49 offen offset:1024 sc1 lds
    s_mov_b32 s48, 1
    s_mov_b32 s51, 24576
    s_lshl_b32 s53, s48, 2
    s_lshr_b64 s[54:55], s[100:101], s53
    s_add_u32 s53, s54, s65
    s_and_b32 s53, s53, 15
    s_lshl_b32 s68, 1, s53
    s_mul_i32 s49, s53, 2048
    s_mul_i32 s50, s53, 131072
    s_andn2_b32 s55, s68, s77
    s_cbranch_scc0 rdy_46
    s_mov_b32 exec_lo, 0xffff
    s_mov_b32 exec_hi, 0
    s_mov_b32 s56, 0
nd_45:
    buffer_load_dword v31, v30, s[96:99], s63 offen sc1
    s_add_u32 s56, s56, 1
    s_waitcnt vmcnt(0)
    v_cmp_eq_u32 vcc, s62, v31
    s_nop 1
    s_cmp_gt_u32 s56, 0x20000
    s_cselect_b32 s77, -1, vcc_lo
    s_andn2_b32 s55, s68, s77
    s_cbranch_scc1 nd_45
    s_mov_b64 exec, -1
rdy_46:
    s_add_u32 s56, s51, s57
    s_add_u32 m0, s56, 0
    s_nop 0
    buffer_load_dwordx4 v10, s[28:31], s49 offen sc1 lds
    buffer_load_dwordx4 v10, s[28:31], s49 offen offset:1024 sc1 lds
    s_add_u32 m0, s56, 2048
    s_nop 0
    buffer_load_dwordx4 v11, s[28:31], s49 offen sc1 lds
    buffer_load_dwordx4 v11, s[28:31], s49 offen offset:1024 sc1 lds
    s_mov_b32 s48, 2
    s_mov_b32 s51, 49152
    s_lshl_b32 s53, s48, 2
    s_lshr_b64 s[54:55], s[100:101], s53
    s_add_u32 s53, s54, s65
    s_and_b32 s53, s53, 15
    s_lshl_b32 s68, 1, s53
    s_mul_i32 s49, s53, 2048
    s_mul_i32 s50, s53, 131072
    s_andn2_b32 s55, s68, s77
    s_cbranch_scc0 rdy_48
    s_mov_b32 exec_lo, 0xffff
    s_mov_b32 exec_hi, 0
    s_mov_b32 s56, 0
nd_47:
    buffer_load_dword v31, v30, s[96:99], s63 offen sc1
    s_add_u32 s56, s56, 1
    s_waitcnt vmcnt(0)
    v_cmp_eq_u32 vcc, s62, v31
    s_nop 1
    s_cmp_gt_u32 s56, 0x20000
    s_cselect_b32 s77, -1, vcc_lo
    s_andn2_b32 s55, s68, s77
    s_cbranch_scc1 nd_47
    s_mov_b64 exec, -1
rdy_48:
    s_add_u32 s56, s51, s57
    s_add_u32 m0, s56, 0
    s_nop 0
    buffer_load_dwordx4 v10, s[28:31], s49 offen sc1 lds
    buffer_load_dwordx4 v10, s[28:31], s49 offen offset:1024 sc1 lds
    s_add_u32 m0, s56, 2048
    s_nop 0
    buffer_load_dwordx4 v11, s[28:31], s49 offen sc1 lds
    buffer_load_dwordx4 v11, s[28:31], s49 offen offset:1024 sc1 lds
    s_waitcnt vmcnt(8)
    s_barrier
    s_mov_b32 s48, 3
    s_mov_b32 s51, 73728
    s_lshl_b32 s53, s48, 2
    s_lshr_b64 s[54:55], s[100:101], s53
    s_add_u32 s53, s54, s65
    s_and_b32 s53, s53, 15
    s_lshl_b32 s68, 1, s53
    s_mul_i32 s49, s53, 2048
    s_mul_i32 s50, s53, 131072
    s_andn2_b32 s55, s68, s77
    s_cbranch_scc0 rdy_50
    s_mov_b32 exec_lo, 0xffff
    s_mov_b32 exec_hi, 0
    s_mov_b32 s56, 0
nd_49:
    buffer_load_dword v31, v30, s[96:99], s63 offen sc1
    s_add_u32 s56, s56, 1
    s_waitcnt vmcnt(0)
    v_cmp_eq_u32 vcc, s62, v31
    s_nop 1
    s_cmp_gt_u32 s56, 0x20000
    s_cselect_b32 s77, -1, vcc_lo
    s_andn2_b32 s55, s68, s77
    s_cbranch_scc1 nd_49
    s_mov_b64 exec, -1
rdy_50:
    s_add_u32 s56, s51, s57
    s_add_u32 m0, s56, 0
    s_nop 0
    buffer_load_dwordx4 v10, s[28:31], s49 offen sc1 lds
    buffer_load_dwordx4 v10, s[28:31], s49 offen offset:1024 sc1 lds
    s_add_u32 m0, s56, 2048
    s_nop 0
    buffer_load_dwordx4 v11, s[28:31], s49 offen sc1 lds
    buffer_load_dwordx4 v11, s[28:31], s49 offen offset:1024 sc1 lds
    s_mov_b32 s48, 4
    s_mov_b32 s51, 98304
    s_lshl_b32 s53, s48, 2
    s_lshr_b64 s[54:55], s[100:101], s53
    s_add_u32 s53, s54, s65
    s_and_b32 s53, s53, 15
    s_lshl_b32 s68, 1, s53
    s_mul_i32 s49, s53, 2048
    s_mul_i32 s50, s53, 131072
    s_andn2_b32 s55, s68, s77
    s_cbranch_scc0 rdy_52
    s_mov_b32 exec_lo, 0xffff
    s_mov_b32 exec_hi, 0
    s_mov_b32 s56, 0
nd_51:
    buffer_load_dword v31, v30, s[96:99], s63 offen sc1
    s_add_u32 s56, s56, 1
    s_waitcnt vmcnt(0)
    v_cmp_eq_u32 vcc, s62, v31
    s_nop 1
    s_cmp_gt_u32 s56, 0x20000
    s_cselect_b32 s77, -1, vcc_lo
    s_andn2_b32 s55, s68, s77
    s_cbranch_scc1 nd_51
    s_mov_b64 exec, -1
rdy_52:
    s_add_u32 s56, s51, s57
    s_add_u32 m0, s56, 0
    s_nop 0
    buffer_load_dwordx4 v10, s[28:31], s49 offen sc1 lds
    buffer_load_dwordx4 v10, s[28:31], s49 offen offset:1024 sc1 lds
    s_add_u32 m0, s56, 2048
    s_nop 0
    buffer_load_dwordx4 v11, s[28:31], s49 offen sc1 lds
    buffer_load_dwordx4 v11, s[28:31], s49 offen offset:1024 sc1 lds
    s_waitcnt vmcnt(12)
    s_barrier
    s_mov_b32 s48, 5
    s_mov_b32 s51, 0
    s_lshl_b32 s53, s48, 2
    s_lshr_b64 s[54:55], s[100:101], s53
    s_add_u32 s53, s54, s65
    s_and_b32 s53, s53, 15
    s_lshl_b32 s68, 1, s53
    s_mul_i32 s49, s53, 2048
    s_mul_i32 s50, s53, 131072
    s_andn2_b32 s55, s68, s77
    s_cbranch_scc0 rdy_54
    s_mov_b32 exec_lo, 0xffff
    s_mov_b32 exec_hi, 0
    s_mov_b32 s56, 0
nd_53:
    buffer_load_dword v31, v30, s[96:99], s63 offen sc1
    s_add_u32 s56, s56, 1
    s_waitcnt vmcnt(0)
    v_cmp_eq_u32 vcc, s62, v31
    s_nop 1
    s_cmp_gt_u32 s56, 0x20000
    s_cselect_b32 s77, -1, vcc_lo
    s_andn2_b32 s55, s68, s77
    s_cbranch_scc1 nd_53
    s_mov_b64 exec, -1
rdy_54:
    s_add_u32 s56, s51, s57
    s_add_u32 m0, s56, 0
    s_nop 0
    buffer_load_dwordx4 v10, s[28:31], s49 offen sc1 lds
    buffer_load_dwordx4 v10, s[28:31], s49 offen offset:1024 sc1 lds
    s_add_u32 m0, s56, 2048
    s_nop 0
    buffer_load_dwordx4 v11, s[28:31], s49 offen sc1 lds
    buffer_load_dwordx4 v11, s[28:31], s49 offen offset:1024 sc1 lds
    s_add_u32 s56, s51, s58
    s_add_u32 m0, s56, 16384
    s_nop 0
    buffer_load_dwordx4 v12, s[32:35], s50 offen lds
    s_add_u32 m0, s56, 17408
    s_nop 0
    buffer_load_dwordx4 v13, s[32:35], s50 offen lds
    s_waitcnt vmcnt(14)
    s_barrier
    s_mov_b32 s48, 6
    s_mov_b32 s51, 24576
    s_lshl_b32 s53, s48, 2
    s_lshr_b64 s[54:55], s[100:101], s53
    s_add_u32 s53, s54, s65
    s_and_b32 s53, s53, 15
    s_lshl_b32 s68, 1, s53
    s_mul_i32 s49, s53, 2048
    s_mul_i32 s50, s53, 131072
    s_andn2_b32 s55, s68, s77
    s_cbranch_scc0 rdy_56
    s_mov_b32 exec_lo, 0xffff
    s_mov_b32 exec_hi, 0
    s_mov_b32 s56, 0
nd_55:
    buffer_load_dword v31, v30, s[96:99], s63 offen sc1
    s_add_u32 s56, s56, 1
    s_waitcnt vmcnt(0)
    v_cmp_eq_u32 vcc, s62, v31
    s_nop 1
    s_cmp_gt_u32 s56, 0x20000
    s_cselect_b32 s77, -1, vcc_lo
    s_andn2_b32 s55, s68, s77
    s_cbranch_scc1 nd_55
    s_mov_b64 exec, -1
rdy_56:
    s_add_u32 s56, s51, s57
    s_add_u32 m0, s56, 0
    s_nop 0
    buffer_load_dwordx4 v10, s[28:31], s49 offen sc1 lds
    buffer_load_dwordx4 v10, s[28:31], s49 offen offset:1024 sc1 lds
    s_add_u32 m0, s56, 2048
    s_nop 0
    buffer_load_dwordx4 v11, s[28:31], s49 offen sc1 lds
    buffer_load_dwordx4 v11, s[28:31], s49 offen offset:1024 sc1 lds
    s_add_u32 s56, s51, s58
    s_add_u32 m0, s56, 16384
    s_nop 0
    buffer_load_dwordx4 v12, s[32:35], s50 offen lds
    s_add_u32 m0, s56, 17408
    s_nop 0
    buffer_load_dwordx4 v13, s[32:35], s50 offen lds
    s_waitcnt vmcnt(16)
    s_barrier
    s_mov_b32 s48, 7
    s_mov_b32 s51, 49152
    s_lshl_b32 s53, s48, 2
    s_lshr_b64 s[54:55], s[100:101], s53
    s_add_u32 s53, s54, s65
    s_and_b32 s53, s53, 15
    s_lshl_b32 s68, 1, s53
    s_mul_i32 s49, s53, 2048
    s_mul_i32 s50, s53, 131072
    s_andn2_b32 s55, s68, s77
    s_cbranch_scc0 rdy_58
    s_mov_b32 exec_lo, 0xffff
    s_mov_b32 exec_hi, 0
    s_mov_b32 s56, 0
nd_57:
    buffer_load_dword v31, v30, s[96:99], s63 offen sc1
    s_add_u32 s56, s56, 1
    s_waitcnt vmcnt(0)
    v_cmp_eq_u32 vcc, s62, v31
    s_nop 1
    s_cmp_gt_u32 s56, 0x20000
    s_cselect_b32 s77, -1, vcc_lo
    s_andn2_b32 s55, s68, s77
    s_cbranch_scc1 nd_57
    s_mov_b64 exec, -1
rdy_58:
    s_add_u32 s56, s51, s57
    s_add_u32 m0, s56, 0
    s_nop 0
    buffer_load_dwordx4 v10, s[28:31], s49 offen sc1 lds
    buffer_load_dwordx4 v10, s[28:31], s49 offen offset:1024 sc1 lds
    s_add_u32 m0, s56, 2048
    s_nop 0
    buffer_load_dwordx4 v11, s[28:31], s49 offen sc1 lds
    buffer_load_dwordx4 v11, s[28:31], s49 offen offset:1024 sc1 lds
    s_add_u32 s56, s51, s58
    s_add_u32 m0, s56, 16384
    s_nop 0
    buffer_load_dwordx4 v12, s[32:35], s50 offen lds
    s_add_u32 m0, s56, 17408
    s_nop 0
    buffer_load_dwordx4 v13, s[32:35], s50 offen lds
    s_waitcnt vmcnt(18)
    s_barrier
    s_mov_b32 s48, 8
    s_mov_b32 s51, 73728
    s_lshl_b32 s53, s48, 2
    s_lshr_b64 s[54:55], s[100:101], s53
    s_add_u32 s53, s54, s65
    s_and_b32 s53, s53, 15
    s_lshl_b32 s68, 1, s53
    s_mul_i32 s49, s53, 2048
    s_mul_i32 s50, s53, 131072
    s_andn2_b32 s55, s68, s77
    s_cbranch_scc0 rdy_60
    s_mov_b32 exec_lo, 0xffff
    s_mov_b32 exec_hi, 0
    s_mov_b32 s56, 0
nd_59:
    buffer_load_dword v31, v30, s[96:99], s63 offen sc1
    s_add_u32 s56, s56, 1
    s_waitcnt vmcnt(0)
    v_cmp_eq_u32 vcc, s62, v31
    s_nop 1
    s_cmp_gt_u32 s56, 0x20000
    s_cselect_b32 s77, -1, vcc_lo
    s_andn2_b32 s55, s68, s77
    s_cbranch_scc1 nd_59
    s_mov_b64 exec, -1
rdy_60:
    s_add_u32 s56, s51, s57
    s_add_u32 m0, s56, 0
    s_nop 0
    buffer_load_dwordx4 v10, s[28:31], s49 offen sc1 lds
    buffer_load_dwordx4 v10, s[28:31], s49 offen offset:1024 sc1 lds
    s_add_u32 m0, s56, 2048
    s_nop 0
    buffer_load_dwordx4 v11, s[28:31], s49 offen sc1 lds
    buffer_load_dwordx4 v11, s[28:31], s49 offen offset:1024 sc1 lds
    s_add_u32 s56, s51, s58
    s_add_u32 m0, s56, 16384
    s_nop 0
    buffer_load_dwordx4 v12, s[32:35], s50 offen lds
    s_add_u32 m0, s56, 17408
    s_nop 0
    buffer_load_dwordx4 v13, s[32:35], s50 offen lds
    s_mov_b32 s48, 9
    s_mov_b32 s51, 98304
    s_lshl_b32 s53, s48, 2
    s_lshr_b64 s[54:55], s[100:101], s53
    s_add_u32 s53, s54, s65
    s_and_b32 s53, s53, 15
    s_lshl_b32 s68, 1, s53
    s_mul_i32 s49, s53, 2048
    s_mul_i32 s50, s53, 131072
    s_add_u32 s47, s51, s57
    s_add_u32 m0, s47, 0
ploop_61:
    s_waitcnt vmcnt(18)
    s_barrier
    s_andn2_b32 s55, s68, s77
    s_cbranch_scc0 rdy_63
    s_mov_b32 exec_lo, 0xffff
    s_mov_b32 exec_hi, 0
    s_mov_b32 s56, 0
nd_62:
    buffer_load_dword v31, v30, s[96:99], s63 offen sc1
    s_add_u32 s56, s56, 1
    s_waitcnt vmcnt(0)
    v_cmp_eq_u32 vcc, s62, v31
    s_nop 1
    s_cmp_gt_u32 s56, 0x20000
    s_cselect_b32 s77, -1, vcc_lo
    s_andn2_b32 s55, s68, s77
    s_cbranch_scc1 nd_62
    s_mov_b64 exec, -1
rdy_63:
    buffer_load_dwordx4 v10, s[28:31], s49 offen sc1 lds
    buffer_load_dwordx4 v10, s[28:31], s49 offen offset:1024 sc1 lds
    s_cmp_lg_u32 s48, 10
    s_cbranch_scc1 ct_64
    s_getpc_b64 s[78:79]
pc_65:
    s_sub_u32 s78, s78, pc_65-KSTART-60
    s_subb_u32 s79, s79, 0
    s_lshr_b32 s53, s2, 3
    s_lshl_b32 s53, s53, 2
    s_add_u32 s53, s53, s27
    s_lshl_b32 s53, s53, 7
    s_add_u32 s54, s53, 0
    s_min_u32 s54, s54, KEND-KSTART-68
    s_load_dwordx2 s[66:67], s[78:79], s54
    s_add_u32 s54, s53, 16384
    s_min_u32 s54, s54, KEND-KSTART-68
    s_load_dwordx2 s[66:67], s[78:79], s54
    s_add_u32 s54, s53, 32768
    s_min_u32 s54, s54, KEND-KSTART-68
    s_load_dwordx2 s[66:67], s[78:79], s54
ct_64:
    s_add_u32 m0, s47, 2048
    s_add_u32 s52, s48, 1
    buffer_load_dwordx4 v11, s[28:31], s49 offen sc1 lds
    s_lshl_b32 s53, s52, 2
    buffer_load_dwordx4 v11, s[28:31], s49 offen offset:1024 sc1 lds
    s_lshr_b64 s[54:55], s[100:101], s53
    s_add_u32 s47, s51, s58
    s_add_u32 m0, s47, 16384
    s_add_u32 s53, s54, s65
    buffer_load_dwordx4 v12, s[32:35], s50 offen lds
    s_and_b32 s53, s53, 15
    s_add_u32 m0, s47, 17408
    s_lshl_b32 s68, 1, s53
    buffer_load_dwordx4 v13, s[32:35], s50 offen lds
    s_mul_i32 s3, s53, 2048
    s_mul_i32 s64, s53, 131072
    s_add_u32 s51, s51, 24576
    s_cmp_ge_u32 s51, 122880
    s_cselect_b32 s51, 0, s51
    s_mov_b32 s49, s3
    s_mov_b32 s50, s64
    s_mov_b32 s48, s52
    s_add_u32 s47, s51, s57
    s_add_u32 m0, s47, 0
    s_cmp_lt_u32 s48, 16
    s_cbranch_scc1 ploop_61
    s_waitcnt vmcnt(18)
    s_barrier
    s_waitcnt vmcnt(12)
    s_barrier
    s_waitcnt vmcnt(6)
    s_barrier
    s_waitcnt vmcnt(0)
    s_barrier
    s_barrier
    s_and_b32 s53, s2, 1
    s_lshl_b32 s53, s53, 3
    s_lshr_b32 s54, s2, 3
    s_and_b32 s55, s54, 7
    s_add_u32 s44, s53, s55
    s_and_b32 s53, s2, 7
    s_lshr_b32 s53, s53, 1
    s_lshl_b32 s53, s53, 2
    s_lshr_b32 s54, s2, 6
    s_add_u32 s45, s53, s54
    s_add_u32 s47, s44, s45
    s_and_b32 s47, s47, 3
    s_add_u32 s28, s24, 8388608
    s_addc_u32 s29, s25, 0
    s_mov_b32 s30, 4194304
    s_mov_b32 s31, 0x20000
    s_mov_b32 s32, s12
    s_mov_b32 s33, s13
    s_mov_b32 s34, 7340032
    s_mov_b32 s35, 0x20000
    s_lshl_b32 s57, s27, 12
    s_lshl_b32 s58, s27, 11
    s_lshl_b32 s59, s27, 10
    s_lshl_b32 s53, s44, 3
    s_lshl_b32 s54, s27, 1
    s_add_u32 s53, s53, s54
    s_lshl_b32 s53, s53, 15
    v_lshlrev_b32 v10, 4, v0
    v_add_u32 v10, s53, v10
    v_add_u32 v11, 0x8000, v10
    s_mul_i32 s53, s45, 448
    s_and_b32 s54, s45, 1
    s_lshl_b32 s55, s54, 6
    s_add_u32 s55, s55, s53
    s_cmp_eq_u32 s54, 0
    s_cselect_b32 s54, 384, 0
    s_add_u32 s54, s54, s53
    s_mul_i32 s53, s27, 114688
    s_add_u32 s55, s55, s53
    s_add_u32 s54, s54, s53
    v_lshrrev_b32 v20, 3, v0
    v_bfe_u32 v21, v0, 4, 2
    v_lshlrev_b32 v21, 1, v21
    v_and_b32 v12, 7, v0
    v_xor_b32 v12, v12, v21
    v_lshlrev_b32 v12, 4, v12
    v_mul_u32_u24 v20, 7168, v20
    v_add_u32 v12, v12, v20
    v_add_u32 v12, s55, v12
    v_add_u32 v13, 57344, v12
    v_add_u32 v14, 128, v12
    v_add_u32 v15, 57472, v12
    v_add_u32 v16, 256, v12
    v_add_u32 v17, 57600, v12
    v_lshrrev_b32 v20, 2, v0
    v_bfe_u32 v21, v0, 4, 1
    v_lshlrev_b32 v21, 1, v21
    v_and_b32 v18, 3, v0
    v_xor_b32 v18, v18, v21
    v_lshlrev_b32 v18, 4, v18
    v_mul_u32_u24 v20, 7168, v20
    v_add_u32 v18, v18, v20
    v_add_u32 v18, s54, v18
    s_and_b32 s65, s44, 8
    s_and_b32 s81, s44, 7
    s_lshl_b32 s74, s2, 2
    s_add_u32 s74, s74, s27
    s_mul_i32 s74, s74, 448
    s_mov_b32 s75, 3670016
    s_mov_b32 s100, 0x86534210
    s_mov_b32 s101, 0xfedbca97
    s_cmp_eq_u32 s47, 1
    s_cselect_b32 s100, 0x76453201, s100
    s_cselect_b32 s101, 0xfecdba89, s101
    s_cmp_eq_u32 s47, 2
    s_cselect_b32 s100, 0x75643120, s100
    s_cselect_b32 s101, 0xfdecb9a8, s101
    s_cmp_eq_u32 s47, 3
    s_cselect_b32 s100, 0x67542310, s100
    s_cselect_b32 s101, 0xefdcab98, s101
    s_mov_b32 s48, 0
    s_mov_b32 s51, 0
    s_lshl_b32 s53, s48, 2
    s_lshr_b64 s[54:55], s[100:101], s53
    s_add_u32 s53, s54, s65
    s_and_b32 s53, s53, 15
    s_mul_i32 s49, s53, 2048
    s_mul_i32 s50, s53, 458752
    s_add_u32 s56, s51, s58
    s_add_u32 m0, s56, 16384
    s_waitcnt vmcnt(6)
    buffer_load_dwordx4 v12, s[32:35], s50 offen lds
    s_add_u32 m0, s56, 17408
    s_waitcnt vmcnt(6)
    buffer_load_dwordx4 v13, s[32:35], s50 offen lds
    s_add_u32 m0, s56, 24576
    s_waitcnt vmcnt(6)
    buffer_load_dwordx4 v14, s[32:35], s50 offen lds
    s_add_u32 m0, s56, 25600
    s_waitcnt vmcnt(6)
    buffer_load_dwordx4 v15, s[32:35], s50 offen lds
    s_add_u32 m0, s56, 32768
    s_waitcnt vmcnt(6)
    buffer_load_dwordx4 v16, s[32:35], s50 offen lds
    s_add_u32 m0, s56, 33792
    s_waitcnt vmcnt(6)
    buffer_load_dwordx4 v17, s[32:35], s50 offen lds
    s_add_u32 s56, s51, s59
    s_add_u32 m0, s56, 40960
    s_waitcnt vmcnt(6)
    buffer_load_dwordx4 v18, s[32:35], s50 offen lds
    s_mov_b32 s48, 1
    s_mov_b32 s51, 45056
    s_lshl_b32 s53, s48, 2
    s_lshr_b64 s[54:55], s[100:101], s53
    s_add_u32 s53, s54, s65
    s_and_b32 s53, s53, 15
    s_mul_i32 s49, s53, 2048
    s_mul_i32 s50, s53, 458752
    s_add_u32 s56, s51, s58
    s_add_u32 m0, s56, 16384
    s_waitcnt vmcnt(6)
    buffer_load_dwordx4 v12, s[32:35], s50 offen lds
    s_add_u32 m0, s56, 17408
    s_waitcnt vmcnt(6)
    buffer_load_dwordx4 v13, s[32:35], s50 offen lds
    s_add_u32 m0, s56, 24576
    s_waitcnt vmcnt(6)
    buffer_load_dwordx4 v14, s[32:35], s50 offen lds
    s_add_u32 m0, s56, 25600
    s_waitcnt vmcnt(6)
    buffer_load_dwordx4 v15, s[32:35], s50 offen lds
    s_add_u32 m0, s56, 32768
    s_waitcnt vmcnt(6)
    buffer_load_dwordx4 v16, s[32:35], s50 offen lds
    s_add_u32 m0, s56, 33792
    s_waitcnt vmcnt(6)
    buffer_load_dwordx4 v17, s[32:35], s50 offen lds
    s_add_u32 s56, s51, s59
    s_add_u32 m0, s56, 40960
    s_waitcnt vmcnt(6)
    buffer_load_dwordx4 v18, s[32:35], s50 offen lds
    s_mov_b32 s48, 2
    s_mov_b32 s51, 90112
    s_lshl_b32 s53, s48, 2
    s_lshr_b64 s[54:55], s[100:101], s53
    s_add_u32 s53, s54, s65
    s_and_b32 s53, s53, 15
    s_mul_i32 s49, s53, 2048
    s_mul_i32 s50, s53, 458752
    s_add_u32 s56, s51, s58
    s_add_u32 m0, s56, 16384
    s_waitcnt vmcnt(6)
    buffer_load_dwordx4 v12, s[32:35], s50 offen lds
    s_add_u32 m0, s56, 17408
    s_waitcnt vmcnt(6)
    buffer_load_dwordx4 v13, s[32:35], s50 offen lds
    s_add_u32 m0, s56, 24576
    s_waitcnt vmcnt(6)
    buffer_load_dwordx4 v14, s[32:35], s50 offen lds
    s_add_u32 m0, s56, 25600
    s_waitcnt vmcnt(6)
    buffer_load_dwordx4 v15, s[32:35], s50 offen lds
    s_add_u32 m0, s56, 32768
    s_waitcnt vmcnt(6)
    buffer_load_dwordx4 v16, s[32:35], s50 offen lds
    s_add_u32 m0, s56, 33792
    s_waitcnt vmcnt(6)
    buffer_load_dwordx4 v17, s[32:35], s50 offen lds
    s_add_u32 s56, s51, s59
    s_add_u32 m0, s56, 40960
    s_waitcnt vmcnt(6)
    buffer_load_dwordx4 v18, s[32:35], s50 offen lds
    v_lshrrev_b32 v20, 2, v0
    v_bfe_u32 v21, v0, 3, 2
    v_xor_b32 v21, s27, v21
    v_lshlrev_b32 v21, 5, v21
    v_lshlrev_b32 v20, 7, v20
    v_add_u32 v40, v20, v21
    v_and_b32 v20, 3, v0
    v_lshlrev_b32 v20, 3, v20
    v_add_u32 v40, v40, v20
    v_add_u32 v40, 16384, v40
    s_and_b32 s53, s27, 1
    v_lshrrev_b32 v20, 2, v0
    v_bfe_u32 v21, v0, 4, 1
    v_xor_b32 v21, s53, v21
    v_lshlrev_b32 v21, 5, v21
    v_lshlrev_b32 v20, 6, v20
    v_add_u32 v39, v20, v21
    v_and_b32 v20, 3, v0
    v_lshlrev_b32 v20, 3, v20
    v_add_u32 v39, v39, v20
    v_add_u32 v39, 40960, v39
    s_mov_b32 s69, 0
    s_mov_b64 s[54:55], s[100:101]
ds_66:
    s_and_b32 s53, s54, 15
    s_cmp_eq_u32 s53, s81
    s_cbranch_scc1 dk_67
    s_lshr_b64 s[54:55], s[54:55], 4
    s_add_u32 s69, s69, 1
    s_cmp_lt_u32 s69, 15
    s_cbranch_scc1 ds_66
dk_67:
    s_mul_i32 s53, s69, 43
    s_lshr_b32 s53, s53, 7
    s_mul_i32 s53, s53, 3
    s_sub_u32 s53, s69, s53
    s_mul_i32 s53, s53, 45056
    v_add_u32 v40, s53, v40
    v_add_u32 v39, s53, v39
    s_add_u32 s69, s69, 2
    s_add_u32 s76, s81, s65
    s_and_b32 s76, s76, 15
    s_and_b32 s53, s27, 1
    v_mov_b32 v44, 0x3f803f80
    v_mov_b32 v45, 0x3f803f80
    v_mov_b32 v46, 0x3f803f80
    v_mov_b32 v47, 0x3f803f80
    s_mul_i32 s54, s45, 224
    s_and_b32 s55, s45, 1
    s_lshl_b32 s56, s55, 5
    s_add_u32 s56, s56, s54
    s_lshl_b32 s84, s27, 4
    s_add_u32 s56, s56, s84
    s_cmp_eq_u32 s55, 0
    s_cselect_b32 s55, 192, 0
    s_add_u32 s55, s55, s54
    s_lshl_b32 s53, s53, 4
    s_add_u32 s55, s55, s53
    v_lshrrev_b32 v20, 4, v0
    v_lshlrev_b32 v41, 6, v20
    v_add_u32 v41, s56, v41
    v_mov_b32 v21, s55
    v_cmp_eq_u32 s[86:87], 1, v20
    v_cmp_eq_u32 s[88:89], 2, v20
    v_cmp_eq_u32 s[90:91], 3, v20
    v_and_b32 v22, 15, v0
    s_nop 0
    v_cndmask_b32 v41, v41, v21, s[90:91]
    v_add_lshl_u32 v41, v41, v22, 2
    s_mul_i32 s84, s76, 14336
    s_add_u32 s84, s84, 1048576
    s_lshl_b32 s83, s45, 8
    s_add_u32 s83, s83, 20480
    s_lshl_b32 s82, s76, 4
    s_lshl_b32 s53, s27, 2
    s_add_u32 s82, s82, s53
    s_add_u32 s82, s82, s83
    s_add_u32 s36, s24, 29360128
    s_addc_u32 s37, s25, 0
    s_mov_b32 s38, 2097152
    s_mov_b32 s39, 0x20000
    s_mov_b32 s40, s14
    s_mov_b32 s41, s15
    s_mov_b32 s42, 7168
    s_mov_b32 s43, 0x20000
    v_lshlrev_b32 v22, 4, v0
    s_lshl_b32 s80, s44, 14
    s_add_u32 s80, s80, s57
    s_mul_i32 s53, s45, 224
    s_and_b32 s54, s45, 1
    s_lshl_b32 s55, s54, 5
    s_add_u32 s55, s55, s53
    s_cmp_eq_u32 s54, 0
    s_cselect_b32 s54, 0, 192
    s_sub_u32 s54, s53, s54
    s_mul_i32 s53, s27, 14
    v_and_b32 v23, 15, v0
    v_min_u32 v23, 13, v23
    v_add_u32 v23, s53, v23
    v_lshlrev_b32 v23, 2, v23
    v_cmp_gt_u32 vcc, 192, v23
    v_mov_b32 v24, s54
    v_mov_b32 v25, s55
    v_cndmask_b32 v24, v24, v25, vcc
    v_add_u32 v24, v24, v23
    v_mul_u32_u24 v26, 14336, v20
    v_lshl_add_u32 v26, v24, 2, v26
    v_bfe_u32 v25, v0, 4, 1
    v_lshrrev_b32 v21, 5, v0
    v_lshl_add_u32 v27, v21, 1, v25
    v_add_u32 v23, v23, v27
    v_add_lshl_u32 v24, v24, v27, 1
    v_lshlrev_b32 v23, 2, v23
    v_add_u32 v23, 136192, v23
    v_and_b32 v27, 7, v0
    v_lshl_add_u32 v27, v27, 1, v25
    v_lshl_add_u32 v27, v21, 4, v27
    s_lshl_b32 s53, s27, 8
    s_add_u32 s53, s53, 135168
    v_lshlrev_b32 v27, 3, v27
    v_add_u32 v27, s53, v27
    v_cmp_ne_u32 s[70:71], 0, v25
    v_cmp_ne_u32 s[72:73], 0, v21
    s_barrier
    s_lshl_b32 s63, s44, 7
    s_add_u32 s63, s63, 12288
    s_mov_b32 s77, 0
    s_mov_b32 s48, 0
    s_mov_b32 s51, 0
    s_lshl_b32 s53, s48, 2
    s_lshr_b64 s[54:55], s[100:101], s53
    s_add_u32 s53, s54, s65
    s_and_b32 s53, s53, 15
    s_lshl_b32 s68, 1, s53
    s_mul_i32 s49, s53, 2048
    s_mul_i32 s50, s53, 458752
    s_andn2_b32 s55, s68, s77
    s_cbranch_scc0 rdy_69
    s_mov_b32 exec_lo, 0xffff
    s_mov_b32 exec_hi, 0
    s_mov_b32 s56, 0
nd_68:
    buffer_load_dword v31, v30, s[96:99], s63 offen sc1
    s_add_u32 s56, s56, 1
    s_waitcnt vmcnt(0)
    v_cmp_eq_u32 vcc, s62, v31
    s_nop 1
    s_cmp_gt_u32 s56, 0x20000
    s_cselect_b32 s77, -1, vcc_lo
    s_andn2_b32 s55, s68, s77
    s_cbranch_scc1 nd_68
    s_mov_b64 exec, -1
rdy_69:
    s_add_u32 s56, s51, s57
    s_add_u32 m0, s56, 0
    s_nop 0
    buffer_load_dwordx4 v10, s[28:31], s49 offen sc1 lds
    buffer_load_dwordx4 v10, s[28:31], s49 offen offset:1024 sc1 lds
    s_add_u32 m0, s56, 2048
    s_nop 0
    buffer_load_dwordx4 v11, s[28:31], s49 offen sc1 lds
    buffer_load_dwordx4 v11, s[28:31], s49 offen offset:1024 sc1 lds
    s_mov_b32 s48, 1
    s_mov_b32 s51, 45056
    s_lshl_b32 s53, s48, 2
    s_lshr_b64 s[54:55], s[100:101], s53
    s_add_u32 s53, s54, s65
    s_and_b32 s53, s53, 15
    s_lshl_b32 s68, 1, s53
    s_mul_i32 s49, s53, 2048
    s_mul_i32 s50, s53, 458752
    s_andn2_b32 s55, s68, s77
    s_cbranch_scc0 rdy_71
    s_mov_b32 exec_lo, 0xffff
    s_mov_b32 exec_hi, 0
    s_mov_b32 s56, 0
nd_70:
    buffer_load_dword v31, v30, s[96:99], s63 offen sc1
    s_add_u32 s56, s56, 1
    s_waitcnt vmcnt(0)
    v_cmp_eq_u32 vcc, s62, v31
    s_nop 1
    s_cmp_gt_u32 s56, 0x20000
    s_cselect_b32 s77, -1, vcc_lo
    s_andn2_b32 s55, s68, s77
    s_cbranch_scc1 nd_70
    s_mov_b64 exec, -1
rdy_71:
    s_add_u32 s56, s51, s57
    s_add_u32 m0, s56, 0
    s_nop 0
    buffer_load_dwordx4 v10, s[28:31], s49 offen sc1 lds
    buffer_load_dwordx4 v10, s[28:31], s49 offen offset:1024 sc1 lds
    s_add_u32 m0, s56, 2048
    s_nop 0
    buffer_load_dwordx4 v11, s[28:31], s49 offen sc1 lds
    buffer_load_dwordx4 v11, s[28:31], s49 offen offset:1024 sc1 lds
    s_waitcnt vmcnt(4)
    s_barrier
    s_mov_b32 s48, 2
    s_mov_b32 s51, 90112
    s_lshl_b32 s53, s48, 2
    s_lshr_b64 s[54:55], s[100:101], s53
    s_add_u32 s53, s54, s65
    s_and_b32 s53, s53, 15
    s_lshl_b32 s68, 1, s53
    s_mul_i32 s49, s53, 2048
    s_mul_i32 s50, s53, 458752
    s_andn2_b32 s55, s68, s77
    s_cbranch_scc0 rdy_73
    s_mov_b32 exec_lo, 0xffff
    s_mov_b32 exec_hi, 0
    s_mov_b32 s56, 0
nd_72:
    buffer_load_dword v31, v30, s[96:99], s63 offen sc1
    s_add_u32 s56, s56, 1
    s_waitcnt vmcnt(0)
    v_cmp_eq_u32 vcc, s62, v31
    s_nop 1
    s_cmp_gt_u32 s56, 0x20000
    s_cselect_b32 s77, -1, vcc_lo
    s_andn2_b32 s55, s68, s77
    s_cbranch_scc1 nd_72
    s_mov_b64 exec, -1
rdy_73:
    s_add_u32 s56, s51, s57
    s_add_u32 m0, s56, 0
    s_nop 0
    buffer_load_dwordx4 v10, s[28:31], s49 offen sc1 lds
    buffer_load_dwordx4 v10, s[28:31], s49 offen offset:1024 sc1 lds
    s_add_u32 m0, s56, 2048
    s_nop 0
    buffer_load_dwordx4 v11, s[28:31], s49 offen sc1 lds
    buffer_load_dwordx4 v11, s[28:31], s49 offen offset:1024 sc1 lds
    s_cmp_lg_u32 s48, s69
    s_cbranch_scc1 nd1_74
    ds_read_b64_tr_b16 v[56:57], v40 offset:0
    ds_read_b64_tr_b16 v[58:59], v40 offset:2048
    ds_read_b64_tr_b16 v[60:61], v40 offset:4096
    ds_read_b64_tr_b16 v[62:63], v40 offset:6144
    ds_read_b64_tr_b16 v[64:65], v40 offset:8192
    ds_read_b64_tr_b16 v[66:67], v40 offset:10240
    ds_read_b64_tr_b16 v[68:69], v40 offset:12288
    ds_read_b64_tr_b16 v[70:71], v40 offset:14336
    ds_read_b64_tr_b16 v[72:73], v40 offset:16384
    ds_read_b64_tr_b16 v[74:75], v40 offset:18432
    ds_read_b64_tr_b16 v[76:77], v40 offset:20480
    ds_read_b64_tr_b16 v[78:79], v40 offset:22528
    ds_read_b64_tr_b16 v[80:81], v39 offset:0
    ds_read_b64_tr_b16 v[82:83], v39 offset:1024
    ds_read_b64_tr_b16 v[84:85], v39 offset:2048
    ds_read_b64_tr_b16 v[86:87], v39 offset:3072
    s_waitcnt lgkmcnt(0)
    v_mfma_f32_16x16x32_bf16 v[88:91], v[44:47], v[56:59], 0
    v_mfma_f32_16x16x32_bf16 v[92:95], v[44:47], v[64:67], 0
    v_mfma_f32_16x16x32_bf16 v[96:99], v[44:47], v[72:75], 0
    v_mfma_f32_16x16x32_bf16 v[100:103], v[44:47], v[80:83], 0
    v_mfma_f32_16x16x32_bf16 v[88:91], v[44:47], v[60:63], v[88:91]
    v_mfma_f32_16x16x32_bf16 v[92:95], v[44:47], v[68:71], v[92:95]
    v_mfma_f32_16x16x32_bf16 v[96:99], v[44:47], v[76:79], v[96:99]
    v_mfma_f32_16x16x32_bf16 v[100:103], v[44:47], v[84:87], v[100:103]
    s_nop 6
    v_cndmask_b32 v88, v88, v92, s[86:87]
    v_cndmask_b32 v88, v88, v96, s[88:89]
    v_cndmask_b32 v88, v88, v100, s[90:91]
    buffer_store_dword v88, v41, s[36:39], s84 offen sc1
    s_branch nd2_75
nd1_74:
    s_add_u32 s53, s69, 1
    s_cmp_lg_u32 s48, s53
    s_cbranch_scc1 nd2_75
    s_waitcnt vmcnt(11)
    v_mov_b32 v28, 0
    v_mov_b32 v29, s62
    s_mov_b64 exec, 1
    buffer_store_dword v29, v28, s[96:99], s82 offen sc1
    s_mov_b64 exec, -1
noflag_76:
nd2_75:
    s_waitcnt vmcnt(4)
    s_barrier
    s_mov_b32 s48, 3
    s_mov_b32 s51, 0
    s_lshl_b32 s53, s48, 2
    s_lshr_b64 s[54:55], s[100:101], s53
    s_add_u32 s53, s54, s65
    s_and_b32 s53, s53, 15
    s_lshl_b32 s68, 1, s53
    s_mul_i32 s49, s53, 2048
    s_mul_i32 s50, s53, 458752
    s_andn2_b32 s55, s68, s77
    s_cbranch_scc0 rdy_78
    s_mov_b32 exec_lo, 0xffff
    s_mov_b32 exec_hi, 0
    s_mov_b32 s56, 0
nd_77:
    buffer_load_dword v31, v30, s[96:99], s63 offen sc1
    s_add_u32 s56, s56, 1
    s_waitcnt vmcnt(0)
    v_cmp_eq_u32 vcc, s62, v31
    s_nop 1
    s_cmp_gt_u32 s56, 0x20000
    s_cselect_b32 s77, -1, vcc_lo
    s_andn2_b32 s55, s68, s77
    s_cbranch_scc1 nd_77
    s_mov_b64 exec, -1
rdy_78:
    s_add_u32 s56, s51, s57
    s_add_u32 m0, s56, 0
    s_nop 0
    buffer_load_dwordx4 v10, s[28:31], s49 offen sc1 lds
    buffer_load_dwordx4 v10, s[28:31], s49 offen offset:1024 sc1 lds
    s_add_u32 m0, s56, 2048
    s_nop 0
    buffer_load_dwordx4 v11, s[28:31], s49 offen sc1 lds
    buffer_load_dwordx4 v11, s[28:31], s49 offen offset:1024 sc1 lds
    s_add_u32 s56, s51, s58
    s_add_u32 m0, s56, 16384
    s_nop 0
    buffer_load_dwordx4 v12, s[32:35], s50 offen lds
    s_add_u32 m0, s56, 17408
    s_nop 0
    buffer_load_dwordx4 v13, s[32:35], s50 offen lds
    s_add_u32 m0, s56, 24576
    s_nop 0
    buffer_load_dwordx4 v14, s[32:35], s50 offen lds
    s_add_u32 m0, s56, 25600
    s_nop 0
    buffer_load_dwordx4 v15, s[32:35], s50 offen lds
    s_add_u32 m0, s56, 32768
    s_nop 0
    buffer_load_dwordx4 v16, s[32:35], s50 offen lds
    s_add_u32 m0, s56, 33792
    s_nop 0
    buffer_load_dwordx4 v17, s[32:35], s50 offen lds
    s_add_u32 s56, s51, s59
    s_add_u32 m0, s56, 40960
    s_nop 0
    buffer_load_dwordx4 v18, s[32:35], s50 offen lds
    s_cmp_lg_u32 s48, s69
    s_cbranch_scc1 nd1_79
    ds_read_b64_tr_b16 v[56:57], v40 offset:0
    ds_read_b64_tr_b16 v[58:59], v40 offset:2048
    ds_read_b64_tr_b16 v[60:61], v40 offset:4096
    ds_read_b64_tr_b16 v[62:63], v40 offset:6144
    ds_read_b64_tr_b16 v[64:65], v40 offset:8192
    ds_read_b64_tr_b16 v[66:67], v40 offset:10240
    ds_read_b64_tr_b16 v[68:69], v40 offset:12288
    ds_read_b64_tr_b16 v[70:71], v40 offset:14336
    ds_read_b64_tr_b16 v[72:73], v40 offset:16384
    ds_read_b64_tr_b16 v[74:75], v40 offset:18432
    ds_read_b64_tr_b16 v[76:77], v40 offset:20480
    ds_read_b64_tr_b16 v[78:79], v40 offset:22528
    ds_read_b64_tr_b16 v[80:81], v39 offset:0
    ds_read_b64_tr_b16 v[82:83], v39 offset:1024
    ds_read_b64_tr_b16 v[84:85], v39 offset:2048
    ds_read_b64_tr_b16 v[86:87], v39 offset:3072
    s_waitcnt lgkmcnt(0)
    v_mfma_f32_16x16x32_bf16 v[88:91], v[44:47], v[56:59], 0
    v_mfma_f32_16x16x32_bf16 v[92:95], v[44:47], v[64:67], 0
    v_mfma_f32_16x16x32_bf16 v[96:99], v[44:47], v[72:75], 0
    v_mfma_f32_16x16x32_bf16 v[100:103], v[44:47], v[80:83], 0
    v_mfma_f32_16x16x32_bf16 v[88:91], v[44:47], v[60:63], v[88:91]
    v_mfma_f32_16x16x32_bf16 v[92:95], v[44:47], v[68:71], v[92:95]
    v_mfma_f32_16x16x32_bf16 v[96:99], v[44:47], v[76:79], v[96:99]
    v_mfma_f32_16x16x32_bf16 v[100:103], v[44:47], v[84:87], v[100:103]
    s_nop 6
    v_cndmask_b32 v88, v88, v92, s[86:87]
    v_cndmask_b32 v88, v88, v96, s[88:89]
    v_cndmask_b32 v88, v88, v100, s[90:91]
    buffer_store_dword v88, v41, s[36:39], s84 offen sc1
    s_branch nd2_80
nd1_79:
    s_add_u32 s53, s69, 1
    s_cmp_lg_u32 s48, s53
    s_cbranch_scc1 nd2_80
    s_waitcnt vmcnt(11)
    v_mov_b32 v28, 0
    v_mov_b32 v29, s62
    s_mov_b64 exec, 1
    buffer_store_dword v29, v28, s[96:99], s82 offen sc1
    s_mov_b64 exec, -1
noflag_81:
nd2_80:
    s_waitcnt vmcnt(11)
    s_barrier
    s_mov_b32 s48, 4
    s_mov_b32 s51, 45056
    s_lshl_b32 s53, s48, 2
    s_lshr_b64 s[54:55], s[100:101], s53
    s_add_u32 s53, s54, s65
    s_and_b32 s53, s53, 15
    s_lshl_b32 s68, 1, s53
    s_mul_i32 s49, s53, 2048
    s_mul_i32 s50, s53, 458752
    s_andn2_b32 s55, s68, s77
    s_cbranch_scc0 rdy_83
    s_mov_b32 exec_lo, 0xffff
    s_mov_b32 exec_hi, 0
    s_mov_b32 s56, 0
nd_82:
    buffer_load_dword v31, v30, s[96:99], s63 offen sc1
    s_add_u32 s56, s56, 1
    s_waitcnt vmcnt(0)
    v_cmp_eq_u32 vcc, s62, v31
    s_nop 1
    s_cmp_gt_u32 s56, 0x20000
    s_cselect_b32 s77, -1, vcc_lo
    s_andn2_b32 s55, s68, s77
    s_cbranch_scc1 nd_82
    s_mov_b64 exec, -1
rdy_83:
    s_add_u32 s56, s51, s57
    s_add_u32 m0, s56, 0
    s_nop 0
    buffer_load_dwordx4 v10, s[28:31], s49 offen sc1 lds
    buffer_load_dwordx4 v10, s[28:31], s49 offen offset:1024 sc1 lds
    s_add_u32 m0, s56, 2048
    s_nop 0
    buffer_load_dwordx4 v11, s[28:31], s49 offen sc1 lds
    buffer_load_dwordx4 v11, s[28:31], s49 offen offset:1024 sc1 lds
    s_add_u32 s56, s51, s58
    s_add_u32 m0, s56, 16384
    s_nop 0
    buffer_load_dwordx4 v12, s[32:35], s50 offen lds
    s_add_u32 m0, s56, 17408
    s_nop 0
    buffer_load_dwordx4 v13, s[32:35], s50 offen lds
    s_add_u32 m0, s56, 24576
    s_nop 0
    buffer_load_dwordx4 v14, s[32:35], s50 offen lds
    s_add_u32 m0, s56, 25600
    s_nop 0
    buffer_load_dwordx4 v15, s[32:35], s50 offen lds
    s_add_u32 m0, s56, 32768
    s_nop 0
    buffer_load_dwordx4 v16, s[32:35], s50 offen lds
    s_add_u32 m0, s56, 33792
    s_nop 0
    buffer_load_dwordx4 v17, s[32:35], s50 offen lds
    s_add_u32 s56, s51, s59
    s_add_u32 m0, s56, 40960
    s_nop 0
    buffer_load_dwordx4 v18, s[32:35], s50 offen lds
    s_cmp_lg_u32 s48, s69
    s_cbranch_scc1 nd1_84
    ds_read_b64_tr_b16 v[56:57], v40 offset:0
    ds_read_b64_tr_b16 v[58:59], v40 offset:2048
    ds_read_b64_tr_b16 v[60:61], v40 offset:4096
    ds_read_b64_tr_b16 v[62:63], v40 offset:6144
    ds_read_b64_tr_b16 v[64:65], v40 offset:8192
    ds_read_b64_tr_b16 v[66:67], v40 offset:10240
    ds_read_b64_tr_b16 v[68:69], v40 offset:12288
    ds_read_b64_tr_b16 v[70:71], v40 offset:14336
    ds_read_b64_tr_b16 v[72:73], v40 offset:16384
    ds_read_b64_tr_b16 v[74:75], v40 offset:18432
    ds_read_b64_tr_b16 v[76:77], v40 offset:20480
    ds_read_b64_tr_b16 v[78:79], v40 offset:22528
    ds_read_b64_tr_b16 v[80:81], v39 offset:0
    ds_read_b64_tr_b16 v[82:83], v39 offset:1024
    ds_read_b64_tr_b16 v[84:85], v39 offset:2048
    ds_read_b64_tr_b16 v[86:87], v39 offset:3072
    s_waitcnt lgkmcnt(0)
    v_mfma_f32_16x16x32_bf16 v[88:91], v[44:47], v[56:59], 0
    v_mfma_f32_16x16x32_bf16 v[92:95], v[44:47], v[64:67], 0
    v_mfma_f32_16x16x32_bf16 v[96:99], v[44:47], v[72:75], 0
    v_mfma_f32_16x16x32_bf16 v[100:103], v[44:47], v[80:83], 0
    v_mfma_f32_16x16x32_bf16 v[88:91], v[44:47], v[60:63], v[88:91]
    v_mfma_f32_16x16x32_bf16 v[92:95], v[44:47], v[68:71], v[92:95]
    v_mfma_f32_16x16x32_bf16 v[96:99], v[44:47], v[76:79], v[96:99]
    v_mfma_f32_16x16x32_bf16 v[100:103], v[44:47], v[84:87], v[100:103]
    s_nop 6
    v_cndmask_b32 v88, v88, v92, s[86:87]
    v_cndmask_b32 v88, v88, v96, s[88:89]
    v_cndmask_b32 v88, v88, v100, s[90:91]
    buffer_store_dword v88, v41, s[36:39], s84 offen sc1
    s_branch nd2_85
nd1_84:
    s_add_u32 s53, s69, 1
    s_cmp_lg_u32 s48, s53
    s_cbranch_scc1 nd2_85
    s_waitcnt vmcnt(11)
    v_mov_b32 v28, 0
    v_mov_b32 v29, s62
    s_mov_b64 exec, 1
    buffer_store_dword v29, v28, s[96:99], s82 offen sc1
    s_mov_b64 exec, -1
noflag_86:
nd2_85:
    s_mov_b32 s48, 5
    s_mov_b32 s51, 90112
    s_lshl_b32 s53, s48, 2
    s_lshr_b64 s[54:55], s[100:101], s53
    s_add_u32 s53, s54, s65
    s_and_b32 s53, s53, 15
    s_lshl_b32 s68, 1, s53
    s_mul_i32 s49, s53, 2048
    s_mul_i32 s50, s53, 458752
    s_add_u32 s47, s51, s57
    s_add_u32 m0, s47, 0
ploop_87:
    s_waitcnt vmcnt(11)
    s_barrier
    s_andn2_b32 s55, s68, s77
    s_cbranch_scc0 rdy_89
    s_mov_b32 exec_lo, 0xffff
    s_mov_b32 exec_hi, 0
    s_mov_b32 s56, 0
nd_88:
    buffer_load_dword v31, v30, s[96:99], s63 offen sc1
    s_add_u32 s56, s56, 1
    s_waitcnt vmcnt(0)
    v_cmp_eq_u32 vcc, s62, v31
    s_nop 1
    s_cmp_gt_u32 s56, 0x20000
    s_cselect_b32 s77, -1, vcc_lo
    s_andn2_b32 s55, s68, s77
    s_cbranch_scc1 nd_88
    s_mov_b64 exec, -1
rdy_89:
    buffer_load_dwordx4 v10, s[28:31], s49 offen sc1 lds
    buffer_load_dwordx4 v10, s[28:31], s49 offen offset:1024 sc1 lds
    s_add_u32 m0, s47, 2048
    s_add_u32 s52, s48, 1
    buffer_load_dwordx4 v11, s[28:31], s49 offen sc1 lds
    buffer_load_dwordx4 v11, s[28:31], s49 offen offset:1024 sc1 lds
    s_add_u32 s47, s51, s58
    s_add_u32 m0, s47, 16384
    s_lshl_b32 s53, s52, 2
    buffer_load_dwordx4 v12, s[32:35], s50 offen lds
    s_add_u32 m0, s47, 17408
    s_lshr_b64 s[54:55], s[100:101], s53
    buffer_load_dwordx4 v13, s[32:35], s50 offen lds
    s_add_u32 m0, s47, 24576
    s_add_u32 s53, s54, s65
    buffer_load_dwordx4 v14, s[32:35], s50 offen lds
    s_add_u32 m0, s47, 25600
    s_and_b32 s53, s53, 15
    buffer_load_dwordx4 v15, s[32:35], s50 offen lds
    s_add_u32 m0, s47, 32768
    s_lshl_b32 s68, 1, s53
    buffer_load_dwordx4 v16, s[32:35], s50 offen lds
    s_add_u32 m0, s47, 33792
    s_mul_i32 s3, s53, 2048
    buffer_load_dwordx4 v17, s[32:35], s50 offen lds
    s_add_u32 s47, s51, s59
    s_add_u32 m0, s47, 40960
    s_nop 0
    buffer_load_dwordx4 v18, s[32:35], s50 offen lds
    s_mul_i32 s64, s53, 458752
    s_cmp_lg_u32 s48, s69
    s_cbranch_scc1 nd1_90
    ds_read_b64_tr_b16 v[56:57], v40 offset:0
    ds_read_b64_tr_b16 v[58:59], v40 offset:2048
    ds_read_b64_tr_b16 v[60:61], v40 offset:4096
    ds_read_b64_tr_b16 v[62:63], v40 offset:6144
    ds_read_b64_tr_b16 v[64:65], v40 offset:8192
    ds_read_b64_tr_b16 v[66:67], v40 offset:10240
    ds_read_b64_tr_b16 v[68:69], v40 offset:12288
    ds_read_b64_tr_b16 v[70:71], v40 offset:14336
    ds_read_b64_tr_b16 v[72:73], v40 offset:16384
    ds_read_b64_tr_b16 v[74:75], v40 offset:18432
    ds_read_b64_tr_b16 v[76:77], v40 offset:20480
    ds_read_b64_tr_b16 v[78:79], v40 offset:22528
    ds_read_b64_tr_b16 v[80:81], v39 offset:0
    ds_read_b64_tr_b16 v[82:83], v39 offset:1024
    ds_read_b64_tr_b16 v[84:85], v39 offset:2048
    ds_read_b64_tr_b16 v[86:87], v39 offset:3072
    s_waitcnt lgkmcnt(0)
    v_mfma_f32_16x16x32_bf16 v[88:91], v[44:47], v[56:59], 0
    v_mfma_f32_16x16x32_bf16 v[92:95], v[44:47], v[64:67], 0
    v_mfma_f32_16x16x32_bf16 v[96:99], v[44:47], v[72:75], 0
    v_mfma_f32_16x16x32_bf16 v[100:103], v[44:47], v[80:83], 0
    v_mfma_f32_16x16x32_bf16 v[88:91], v[44:47], v[60:63], v[88:91]
    v_mfma_f32_16x16x32_bf16 v[92:95], v[44:47], v[68:71], v[92:95]
    v_mfma_f32_16x16x32_bf16 v[96:99], v[44:47], v[76:79], v[96:99]
    v_mfma_f32_16x16x32_bf16 v[100:103], v[44:47], v[84:87], v[100:103]
    s_nop 6
    v_cndmask_b32 v88, v88, v92, s[86:87]
    v_cndmask_b32 v88, v88, v96, s[88:89]
    v_cndmask_b32 v88, v88, v100, s[90:91]
    buffer_store_dword v88, v41, s[36:39], s84 offen sc1
    s_branch nd2_91
nd1_90:
    s_add_u32 s53, s69, 1
    s_cmp_lg_u32 s48, s53
    s_cbranch_scc1 nd2_91
    s_waitcnt vmcnt(11)
    v_mov_b32 v28, 0
    v_mov_b32 v29, s62
    s_mov_b64 exec, 1
    buffer_store_dword v29, v28, s[96:99], s82 offen sc1
    s_mov_b64 exec, -1
noflag_92:
nd2_91:
    s_cmp_lg_u32 s48, 14
    s_cbranch_scc1 ct_93
    s_getpc_b64 s[78:79]
pc_94:
    s_sub_u32 s78, s78, pc_94-KSTART-60
    s_subb_u32 s79, s79, 0
    s_lshr_b32 s53, s2, 3
    s_lshl_b32 s53, s53, 2
    s_add_u32 s53, s53, s27
    s_lshl_b32 s53, s53, 7
    s_add_u32 s54, s53, 0
    s_min_u32 s54, s54, KEND-KSTART-68
    s_load_dwordx2 s[66:67], s[78:79], s54
    s_add_u32 s54, s53, 16384
    s_min_u32 s54, s54, KEND-KSTART-68
    s_load_dwordx2 s[66:67], s[78:79], s54
    s_add_u32 s54, s53, 32768
    s_min_u32 s54, s54, KEND-KSTART-68
    s_load_dwordx2 s[66:67], s[78:79], s54
ct_93:
    s_bitcmp1_b32 0x3fe0, s48
    s_cbranch_scc0 lp_95
    s_getreg_b32 s53, hwreg(HW_REG_IB_STS, 8, 4)
    s_cmp_gt_u32 s53, 8
    s_cbranch_scc1 lp_95
    s_cmp_ge_u32 s74, 7340032
    s_cbranch_scc1 lp_95
    s_add_u32 s53, s48, 1
    s_cmp_eq_u32 s53, s69
    s_cbranch_scc1 lp_95
    s_add_u32 s78, s16, s74
    s_addc_u32 s79, s17, 0
    s_load_dwordx2 s[66:67], s[78:79], 60
    s_load_dwordx2 s[66:67], s[78:79], 188
    s_load_dwordx2 s[66:67], s[78:79], 316
    s_load_dword s66, s[78:79], 384
    s_add_u32 s74, s74, s75
    s_sub_u32 s75, 458752, s75
lp_95:
    s_add_u32 s51, s51, 45056
    s_cmp_ge_u32 s51, 135168
    s_cselect_b32 s51, 0, s51
    s_mov_b32 s49, s3
    s_mov_b32 s50, s64
    s_mov_b32 s48, s52
    s_add_u32 s47, s51, s57
    s_add_u32 m0, s47, 0
    s_cmp_lt_u32 s48, 16
    s_cbranch_scc1 ploop_87
    s_waitcnt vmcnt(11)
    s_barrier
    s_lshl_b32 s68, s44, 8
    s_add_u32 s68, s68, 32768
    buffer_load_dword v66, v30, s[96:99], s68 offen sc1
    buffer_load_dwordx4 v[72:75], v22, s[36:39], s80 offen offset:0 sc1
    buffer_load_dwordx4 v[76:79], v22, s[36:39], s80 offen offset:1024 sc1
    buffer_load_dwordx4 v[80:83], v22, s[36:39], s80 offen offset:2048 sc1
    buffer_load_dwordx4 v[84:87], v22, s[36:39], s80 offen offset:3072 sc1
    buffer_load_ushort v64, v24, s[40:43], 0 offen
    buffer_load_dword v65, v30, s[96:99], s83 offen sc1
    s_mov_b32 s53, 1048576
    buffer_load_dwordx4 v[48:51], v26, s[36:39], s53 offen sc1
    s_mov_b32 s53, 1105920
    buffer_load_dwordx4 v[52:55], v26, s[36:39], s53 offen sc1
    s_mov_b32 s53, 1163264
    buffer_load_dwordx4 v[56:59], v26, s[36:39], s53 offen sc1
    s_mov_b32 s53, 1220608
    buffer_load_dwordx4 v[60:63], v26, s[36:39], s53 offen sc1
    s_waitcnt vmcnt(11)
    s_barrier
    s_waitcnt vmcnt(0)
    s_mov_b32 s81, 0
s3chk_96:
    v_cmp_ne_u32 vcc, s62, v66
    s_cbranch_vccz s3ok_97
    s_add_u32 s81, s81, 1
    s_cmp_gt_u32 s81, 0x8000
    s_cbranch_scc1 s3ok_97
    buffer_load_dword v66, v30, s[96:99], s68 offen sc1
    buffer_load_dwordx4 v[72:75], v22, s[36:39], s80 offen offset:0 sc1
    buffer_load_dwordx4 v[76:79], v22, s[36:39], s80 offen offset:1024 sc1
    buffer_load_dwordx4 v[80:83], v22, s[36:39], s80 offen offset:2048 sc1
    buffer_load_dwordx4 v[84:87], v22, s[36:39], s80 offen offset:3072 sc1
    s_waitcnt vmcnt(0)
    s_branch s3chk_96
s3ok_97:
    v_add_f32 v88, v72, v76
    v_add_f32 v89, v74, v78
    v_add_f32 v90, v80, v84
    v_add_f32 v91, v82, v86
    s_mov_b32 s84, 0x3c800000
    s_mov_b32 s85, 0x42800000
    v_add_f32_dpp v88, v88, v88 row_ror:8 row_mask:0xf bank_mask:0xf
    v_add_f32_dpp v89, v89, v89 row_ror:8 row_mask:0xf bank_mask:0xf
    v_add_f32_dpp v90, v90, v90 row_ror:8 row_mask:0xf bank_mask:0xf
    v_add_f32_dpp v91, v91, v91 row_ror:8 row_mask:0xf bank_mask:0xf
    v_mov_b32 v92, v88
    v_mov_b32 v93, v89
    v_mov_b32 v94, v90
    v_mov_b32 v95, v91
    v_permlane16_swap_b32 v92, v88
    v_permlane16_swap_b32 v93, v89
    v_permlane16_swap_b32 v94, v90
    v_permlane16_swap_b32 v95, v91
    v_add_f32 v88, v92, v88
    v_add_f32 v89, v93, v89
    v_add_f32 v90, v94, v90
    v_add_f32 v91, v95, v91
    v_mov_b32 v92, v88
    v_mov_b32 v93, v89
    v_mov_b32 v94, v90
    v_mov_b32 v95, v91
    v_permlane32_swap_b32 v92, v88
    v_permlane32_swap_b32 v93, v89
    v_permlane32_swap_b32 v94, v90
    v_permlane32_swap_b32 v95, v91
    v_add_f32 v88, v92, v88
    v_add_f32 v89, v93, v89
    v_add_f32 v90, v94, v90
    v_add_f32 v91, v95, v91
    v_mul_f32 v88, 0x3a800000, v88
    v_mul_f32 v89, 0x3a800000, v89
    v_mul_f32 v90, 0x3a800000, v90
    v_mul_f32 v91, 0x3a800000, v91
    s_barrier
    s_mov_b32 s81, 0
c3chk_98:
    v_cmp_ne_u32 vcc, s62, v65
    s_cbranch_vccz c3ok_99
    s_add_u32 s81, s81, 1
    s_cmp_gt_u32 s81, 0x8000
    s_cbranch_scc1 c3ok_99
    buffer_load_dword v65, v30, s[96:99], s83 offen sc1
    s_mov_b32 s53, 1048576
    buffer_load_dwordx4 v[48:51], v26, s[36:39], s53 offen sc1
    s_mov_b32 s53, 1105920
    buffer_load_dwordx4 v[52:55], v26, s[36:39], s53 offen sc1
    s_mov_b32 s53, 1163264
    buffer_load_dwordx4 v[56:59], v26, s[36:39], s53 offen sc1
    s_mov_b32 s53, 1220608
    buffer_load_dwordx4 v[60:63], v26, s[36:39], s53 offen sc1
    s_waitcnt vmcnt(0)
    s_branch c3chk_98
c3ok_99:
    v_fma_f32 v72, v72, s84, -v88
    v_fma_f32 v74, v74, s84, -v89
    v_fma_f32 v76, v76, s84, -v88
    v_fma_f32 v78, v78, s84, -v89
    v_fma_f32 v80, v80, s84, -v90
    v_fma_f32 v82, v82, s84, -v91
    v_fma_f32 v84, v84, s84, -v90
    v_fma_f32 v86, v86, s84, -v91
    v_mul_f32 v72, v72, v72
    v_mul_f32 v74, v74, v74
    v_mul_f32 v76, v76, v76
    v_mul_f32 v78, v78, v78
    v_mul_f32 v80, v80, v80
    v_mul_f32 v82, v82, v82
    v_mul_f32 v84, v84, v84
    v_mul_f32 v86, v86, v86
    v_fma_f32 v73, v72, s85, v73
    v_fma_f32 v75, v74, s85, v75
    v_fma_f32 v77, v76, s85, v77
    v_fma_f32 v79, v78, s85, v79
    v_fma_f32 v81, v80, s85, v81
    v_fma_f32 v83, v82, s85, v83
    v_fma_f32 v85, v84, s85, v85
    v_fma_f32 v87, v86, s85, v87
    v_add_f32 v96, v73, v77
    v_add_f32 v97, v75, v79
    v_add_f32 v98, v81, v85
    v_add_f32 v99, v83, v87
    v_pk_add_f32 v[48:49], v[48:49], v[52:53]
    v_pk_add_f32 v[56:57], v[56:57], v[60:61]
    v_pk_add_f32 v[50:51], v[50:51], v[54:55]
    v_pk_add_f32 v[58:59], v[58:59], v[62:63]
    v_pk_add_f32 v[48:49], v[48:49], v[56:57]
    v_pk_add_f32 v[50:51], v[50:51], v[58:59]
    s_nop 1
    v_permlane32_swap_b32 v48, v50
    v_permlane32_swap_b32 v49, v51
    v_add_f32 v48, v48, v50
    v_add_f32 v49, v49, v51
    s_nop 1
    v_permlane16_swap_b32 v48, v49
    v_add_f32 v48, v48, v49
    v_lshlrev_b32 v49, 16, v64
    ds_write_b32 v23, v48
    ds_write_b32 v23, v49 offset:896
    v_add_f32_dpp v96, v96, v96 row_ror:8 row_mask:0xf bank_mask:0xf
    v_add_f32_dpp v97, v97, v97 row_ror:8 row_mask:0xf bank_mask:0xf
    v_add_f32_dpp v98, v98, v98 row_ror:8 row_mask:0xf bank_mask:0xf
    v_add_f32_dpp v99, v99, v99 row_ror:8 row_mask:0xf bank_mask:0xf
    v_mov_b32 v92, v96
    v_mov_b32 v93, v97
    v_mov_b32 v94, v98
    v_mov_b32 v95, v99
    v_permlane16_swap_b32 v92, v96
    v_permlane16_swap_b32 v93, v97
    v_permlane16_swap_b32 v94, v98
    v_permlane16_swap_b32 v95, v99
    v_add_f32 v96, v92, v96
    v_add_f32 v97, v93, v97
    v_add_f32 v98, v94, v98
    v_add_f32 v99, v95, v99
    v_mov_b32 v92, v96
    v_mov_b32 v93, v97
    v_mov_b32 v94, v98
    v_mov_b32 v95, v99
    v_permlane32_swap_b32 v92, v96
    v_permlane32_swap_b32 v93, v97
    v_permlane32_swap_b32 v94, v98
    v_permlane32_swap_b32 v95, v99
    v_add_f32 v96, v92, v96
    v_add_f32 v97, v93, v97
    v_add_f32 v98, v94, v98
    v_add_f32 v99, v95, v99
    v_cndmask_b32 v88, v88, v89, s[70:71]
    v_cndmask_b32 v90, v90, v91, s[70:71]
    v_cndmask_b32 v96, v96, v97, s[70:71]
    v_cndmask_b32 v98, v98, v99, s[70:71]
    v_cndmask_b32 v88, v88, v90, s[72:73]
    v_cndmask_b32 v89, v96, v98, s[72:73]
    v_mul_f32 v89, 0x3a800000, v89
    v_cvt_pk_bf16_f32 v88, v88, v88
    v_and_b32 v88, 0xffff0000, v88
    v_max_f32 v89, 0, v89
    v_cvt_pk_bf16_f32 v89, v89, v89
    v_and_b32 v89, 0xffff0000, v89
    v_add_f32 v89, 0x3727c5ac, v89
    v_cvt_pk_bf16_f32 v89, v89, v89
    v_and_b32 v89, 0xffff0000, v89
    v_sqrt_f32 v89, v89
    s_nop 0
    v_cvt_pk_bf16_f32 v89, v89, v89
    v_and_b32 v89, 0xffff0000, v89
    v_rcp_f32 v89, v89
    s_nop 0
    v_mul_f32 v91, v88, v89
    v_mov_b32 v90, v89
    ds_write_b64 v27, v[90:91]
    v_mov_b32 v20, 137984
    v_mov_b32 v21, 0
    ds_write_b32 v20, v21
    ds_write_b32 v20, v21 offset:4
    s_waitcnt lgkmcnt(0)
    s_barrier
    s_and_b32 s53, s2, 3
    s_lshl_b32 s53, s53, 2
    s_lshr_b32 s54, s2, 3
    s_and_b32 s55, s54, 3
    s_add_u32 s44, s53, s55
    s_bfe_u32 s46, s2, 0x10002
    s_lshr_b32 s45, s2, 5
    s_add_u32 s47, s44, s45
    s_and_b32 s47, s47, 3
    s_add_u32 s28, s24, 12582912
    s_addc_u32 s29, s25, 0
    s_mov_b32 s30, 16777216
    s_mov_b32 s31, 0x20000
    s_mov_b32 s32, s16
    s_mov_b32 s33, s17
    s_mov_b32 s34, 7340032
    s_mov_b32 s35, 0x20000
    s_lshl_b32 s57, s27, 12
    s_lshl_b32 s58, s27, 11
    s_lshl_b32 s53, s44, 3
    s_lshl_b32 s54, s27, 1
    s_add_u32 s54, s53, s54
    s_mul_i32 s54, s54, 114688
    s_mul_i32 s53, s46, 57344
    s_add_u32 s54, s54, s53
    v_lshlrev_b32 v10, 4, v0
    v_add_u32 v10, s54, v10
    v_add_u32 v11, 114688, v10
    s_lshl_b32 s55, s45, 8
    s_lshl_b32 s53, s27, 15
    s_add_u32 s55, s55, s53
    s_mul_i32 s53, s46, 3670016
    s_add_u32 s55, s55, s53
    v_lshrrev_b32 v20, 3, v0
    v_bfe_u32 v21, v0, 4, 2
    v_lshlrev_b32 v21, 1, v21
    v_and_b32 v12, 7, v0
    v_xor_b32 v12, v12, v21
    v_lshlrev_b32 v12, 4, v12
    v_mul_u32_u24 v20, 2048, v20
    v_add_u32 v12, v12, v20
    v_add_u32 v12, s55, v12
    v_add_u32 v13, 16384, v12
    v_add_u32 v14, 128, v12
    v_add_u32 v15, 128, v13
    s_lshr_b32 s65, s44, 2
    s_mul_i32 s65, s65, 0
    s_sub_u32 s65, s65, 1
    s_mov_b32 s100, 0x94949495
    s_mov_b32 s101, 0x549494
    s_cmp_eq_u32 s47, 1
    s_cselect_b32 s100, 0x52525252, s100
    s_cselect_b32 s101, 0x525252, s101
    s_cmp_eq_u32 s47, 2
    s_cselect_b32 s100, 0x49494949, s100
    s_cselect_b32 s101, 0x494949, s101
    s_cmp_eq_u32 s47, 3
    s_cselect_b32 s100, 0x25252525, s100
    s_cselect_b32 s101, 0x252525, s101
    s_mov_b32 s48, 0
    s_mov_b32 s51, 0
    s_lshl_b32 s53, s48, 1
    s_lshr_b64 s[54:55], s[100:101], s53
    s_and_b32 s53, s54, 3
    s_add_u32 s53, s53, s48
    s_add_u32 s53, s53, s65
    s_mul_i32 s49, s53, 2048
    s_mul_i32 s50, s53, 131072
    s_add_u32 s56, s51, s58
    s_add_u32 m0, s56, 16384
    s_waitcnt vmcnt(6)
    buffer_load_dwordx4 v12, s[32:35], s50 offen lds
    s_add_u32 m0, s56, 17408
    s_waitcnt vmcnt(6)
    buffer_load_dwordx4 v13, s[32:35], s50 offen lds
    s_add_u32 m0, s56, 24576
    s_waitcnt vmcnt(6)
    buffer_load_dwordx4 v14, s[32:35], s50 offen lds
    s_add_u32 m0, s56, 25600
    s_waitcnt vmcnt(6)
    buffer_load_dwordx4 v15, s[32:35], s50 offen lds
    s_mov_b32 s48, 1
    s_mov_b32 s51, 32768
    s_lshl_b32 s53, s48, 1
    s_lshr_b64 s[54:55], s[100:101], s53
    s_and_b32 s53, s54, 3
    s_add_u32 s53, s53, s48
    s_add_u32 s53, s53, s65
    s_mul_i32 s49, s53, 2048
    s_mul_i32 s50, s53, 131072
    s_add_u32 s56, s51, s58
    s_add_u32 m0, s56, 16384
    s_waitcnt vmcnt(6)
    buffer_load_dwordx4 v12, s[32:35], s50 offen lds
    s_add_u32 m0, s56, 17408
    s_waitcnt vmcnt(6)
    buffer_load_dwordx4 v13, s[32:35], s50 offen lds
    s_add_u32 m0, s56, 24576
    s_waitcnt vmcnt(6)
    buffer_load_dwordx4 v14, s[32:35], s50 offen lds
    s_add_u32 m0, s56, 25600
    s_waitcnt vmcnt(6)
    buffer_load_dwordx4 v15, s[32:35], s50 offen lds
    s_mov_b32 s48, 2
    s_mov_b32 s51, 65536
    s_lshl_b32 s53, s48, 1
    s_lshr_b64 s[54:55], s[100:101], s53
    s_and_b32 s53, s54, 3
    s_add_u32 s53, s53, s48
    s_add_u32 s53, s53, s65
    s_mul_i32 s49, s53, 2048
    s_mul_i32 s50, s53, 131072
    s_add_u32 s56, s51, s58
    s_add_u32 m0, s56, 16384
    s_waitcnt vmcnt(6)
    buffer_load_dwordx4 v12, s[32:35], s50 offen lds
    s_add_u32 m0, s56, 17408
    s_waitcnt vmcnt(6)
    buffer_load_dwordx4 v13, s[32:35], s50 offen lds
    s_add_u32 m0, s56, 24576
    s_waitcnt vmcnt(6)
    buffer_load_dwordx4 v14, s[32:35], s50 offen lds
    s_add_u32 m0, s56, 25600
    s_waitcnt vmcnt(6)
    buffer_load_dwordx4 v15, s[32:35], s50 offen lds
    s_barrier
    s_lshl_b32 s63, s44, 7
    s_add_u32 s63, s63, 16384
    s_mov_b32 s77, 0
    s_lshl_b32 s54, s46, 5
    s_add_u32 s63, s63, s54
    s_mov_b32 s48, 0
    s_mov_b32 s51, 0
    s_lshl_b32 s53, s48, 1
    s_lshr_b64 s[54:55], s[100:101], s53
    s_and_b32 s53, s54, 3
    s_add_u32 s53, s53, s48
    s_add_u32 s53, s53, s65
    s_mul_i32 s54, s53, 294
    s_add_u32 s55, s54, 147
    s_lshr_b32 s54, s54, 10
    s_lshr_b32 s55, s55, 10
    s_lshl_b32 s54, 1, s54
    s_lshl_b32 s55, 1, s55
    s_or_b32 s68, s54, s55
    s_mul_i32 s49, s53, 2048
    s_mul_i32 s50, s53, 131072
    s_andn2_b32 s55, s68, s77
    s_cbranch_scc0 rdy_101
    s_mov_b32 exec_lo, 0xff
    s_mov_b32 exec_hi, 0
    s_mov_b32 s56, 0
nd_100:
    buffer_load_dword v31, v30, s[96:99], s63 offen sc1
    s_add_u32 s56, s56, 1
    s_waitcnt vmcnt(0)
    v_cmp_eq_u32 vcc, s62, v31
    s_nop 1
    s_cmp_gt_u32 s56, 0x20000
    s_cselect_b32 s77, -1, vcc_lo
    s_andn2_b32 s55, s68, s77
    s_cbranch_scc1 nd_100
    s_mov_b64 exec, -1
rdy_101:
    s_add_u32 s56, s51, s57
    s_add_u32 m0, s56, 0
    s_nop 0
    buffer_load_dwordx4 v10, s[28:31], s49 offen sc1 lds
    buffer_load_dwordx4 v10, s[28:31], s49 offen offset:1024 sc1 lds
    s_add_u32 m0, s56, 2048
    s_nop 0
    buffer_load_dwordx4 v11, s[28:31], s49 offen sc1 lds
    buffer_load_dwordx4 v11, s[28:31], s49 offen offset:1024 sc1 lds
    s_mov_b32 s48, 1
    s_mov_b32 s51, 32768
    s_lshl_b32 s53, s48, 1
    s_lshr_b64 s[54:55], s[100:101], s53
    s_and_b32 s53, s54, 3
    s_add_u32 s53, s53, s48
    s_add_u32 s53, s53, s65
    s_mul_i32 s54, s53, 294
    s_add_u32 s55, s54, 147
    s_lshr_b32 s54, s54, 10
    s_lshr_b32 s55, s55, 10
    s_lshl_b32 s54, 1, s54
    s_lshl_b32 s55, 1, s55
    s_or_b32 s68, s54, s55
    s_mul_i32 s49, s53, 2048
    s_mul_i32 s50, s53, 131072
    s_andn2_b32 s55, s68, s77
    s_cbranch_scc0 rdy_103
    s_mov_b32 exec_lo, 0xff
    s_mov_b32 exec_hi, 0
    s_mov_b32 s56, 0
nd_102:
    buffer_load_dword v31, v30, s[96:99], s63 offen sc1
    s_add_u32 s56, s56, 1
    s_waitcnt vmcnt(0)
    v_cmp_eq_u32 vcc, s62, v31
    s_nop 1
    s_cmp_gt_u32 s56, 0x20000
    s_cselect_b32 s77, -1, vcc_lo
    s_andn2_b32 s55, s68, s77
    s_cbranch_scc1 nd_102
    s_mov_b64 exec, -1
rdy_103:
    s_add_u32 s56, s51, s57
    s_add_u32 m0, s56, 0
    s_nop 0
    buffer_load_dwordx4 v10, s[28:31], s49 offen sc1 lds
    buffer_load_dwordx4 v10, s[28:31], s49 offen offset:1024 sc1 lds
    s_add_u32 m0, s56, 2048
    s_nop 0
    buffer_load_dwordx4 v11, s[28:31], s49 offen sc1 lds
    buffer_load_dwordx4 v11, s[28:31], s49 offen offset:1024 sc1 lds
    s_waitcnt vmcnt(4)
    s_barrier
    s_mov_b32 s48, 2
    s_mov_b32 s51, 65536
    s_lshl_b32 s53, s48, 1
    s_lshr_b64 s[54:55], s[100:101], s53
    s_and_b32 s53, s54, 3
    s_add_u32 s53, s53, s48
    s_add_u32 s53, s53, s65
    s_mul_i32 s54, s53, 294
    s_add_u32 s55, s54, 147
    s_lshr_b32 s54, s54, 10
    s_lshr_b32 s55, s55, 10
    s_lshl_b32 s54, 1, s54
    s_lshl_b32 s55, 1, s55
    s_or_b32 s68, s54, s55
    s_mul_i32 s49, s53, 2048
    s_mul_i32 s50, s53, 131072
    s_andn2_b32 s55, s68, s77
    s_cbranch_scc0 rdy_105
    s_mov_b32 exec_lo, 0xff
    s_mov_b32 exec_hi, 0
    s_mov_b32 s56, 0
nd_104:
    buffer_load_dword v31, v30, s[96:99], s63 offen sc1
    s_add_u32 s56, s56, 1
    s_waitcnt vmcnt(0)
    v_cmp_eq_u32 vcc, s62, v31
    s_nop 1
    s_cmp_gt_u32 s56, 0x20000
    s_cselect_b32 s77, -1, vcc_lo
    s_andn2_b32 s55, s68, s77
    s_cbranch_scc1 nd_104
    s_mov_b64 exec, -1
rdy_105:
    s_add_u32 s56, s51, s57
    s_add_u32 m0, s56, 0
    s_nop 0
    buffer_load_dwordx4 v10, s[28:31], s49 offen sc1 lds
    buffer_load_dwordx4 v10, s[28:31], s49 offen offset:1024 sc1 lds
    s_add_u32 m0, s56, 2048
    s_nop 0
    buffer_load_dwordx4 v11, s[28:31], s49 offen sc1 lds
    buffer_load_dwordx4 v11, s[28:31], s49 offen offset:1024 sc1 lds
    s_waitcnt vmcnt(4)
    s_barrier
    s_mov_b32 s48, 3
    s_mov_b32 s51, 0
    s_lshl_b32 s53, s48, 1
    s_lshr_b64 s[54:55], s[100:101], s53
    s_and_b32 s53, s54, 3
    s_add_u32 s53, s53, s48
    s_add_u32 s53, s53, s65
    s_mul_i32 s54, s53, 294
    s_add_u32 s55, s54, 147
    s_lshr_b32 s54, s54, 10
    s_lshr_b32 s55, s55, 10
    s_lshl_b32 s54, 1, s54
    s_lshl_b32 s55, 1, s55
    s_or_b32 s68, s54, s55
    s_mul_i32 s49, s53, 2048
    s_mul_i32 s50, s53, 131072
    s_andn2_b32 s55, s68, s77
    s_cbranch_scc0 rdy_107
    s_mov_b32 exec_lo, 0xff
    s_mov_b32 exec_hi, 0
    s_mov_b32 s56, 0
nd_106:
    buffer_load_dword v31, v30, s[96:99], s63 offen sc1
    s_add_u32 s56, s56, 1
    s_waitcnt vmcnt(0)
    v_cmp_eq_u32 vcc, s62, v31
    s_nop 1
    s_cmp_gt_u32 s56, 0x20000
    s_cselect_b32 s77, -1, vcc_lo
    s_andn2_b32 s55, s68, s77
    s_cbranch_scc1 nd_106
    s_mov_b64 exec, -1
rdy_107:
    s_add_u32 s56, s51, s57
    s_add_u32 m0, s56, 0
    s_nop 0
    buffer_load_dwordx4 v10, s[28:31], s49 offen sc1 lds
    buffer_load_dwordx4 v10, s[28:31], s49 offen offset:1024 sc1 lds
    s_add_u32 m0, s56, 2048
    s_nop 0
    buffer_load_dwordx4 v11, s[28:31], s49 offen sc1 lds
    buffer_load_dwordx4 v11, s[28:31], s49 offen offset:1024 sc1 lds
    s_add_u32 s56, s51, s58
    s_add_u32 m0, s56, 16384
    s_nop 0
    buffer_load_dwordx4 v12, s[32:35], s50 offen lds
    s_add_u32 m0, s56, 17408
    s_nop 0
    buffer_load_dwordx4 v13, s[32:35], s50 offen lds
    s_add_u32 m0, s56, 24576
    s_nop 0
    buffer_load_dwordx4 v14, s[32:35], s50 offen lds
    s_add_u32 m0, s56, 25600
    s_nop 0
    buffer_load_dwordx4 v15, s[32:35], s50 offen lds
    s_waitcnt vmcnt(8)
    s_barrier
    s_mov_b32 s48, 4
    s_mov_b32 s51, 32768
    s_lshl_b32 s53, s48, 1
    s_lshr_b64 s[54:55], s[100:101], s53
    s_and_b32 s53, s54, 3
    s_add_u32 s53, s53, s48
    s_add_u32 s53, s53, s65
    s_mul_i32 s54, s53, 294
    s_add_u32 s55, s54, 147
    s_lshr_b32 s54, s54, 10
    s_lshr_b32 s55, s55, 10
    s_lshl_b32 s54, 1, s54
    s_lshl_b32 s55, 1, s55
    s_or_b32 s68, s54, s55
    s_mul_i32 s49, s53, 2048
    s_mul_i32 s50, s53, 131072
    s_andn2_b32 s55, s68, s77
    s_cbranch_scc0 rdy_109
    s_mov_b32 exec_lo, 0xff
    s_mov_b32 exec_hi, 0
    s_mov_b32 s56, 0
nd_108:
    buffer_load_dword v31, v30, s[96:99], s63 offen sc1
    s_add_u32 s56, s56, 1
    s_waitcnt vmcnt(0)
    v_cmp_eq_u32 vcc, s62, v31
    s_nop 1
    s_cmp_gt_u32 s56, 0x20000
    s_cselect_b32 s77, -1, vcc_lo
    s_andn2_b32 s55, s68, s77
    s_cbranch_scc1 nd_108
    s_mov_b64 exec, -1
rdy_109:
    s_add_u32 s56, s51, s57
    s_add_u32 m0, s56, 0
    s_nop 0
    buffer_load_dwordx4 v10, s[28:31], s49 offen sc1 lds
    buffer_load_dwordx4 v10, s[28:31], s49 offen offset:1024 sc1 lds
    s_add_u32 m0, s56, 2048
    s_nop 0
    buffer_load_dwordx4 v11, s[28:31], s49 offen sc1 lds
    buffer_load_dwordx4 v11, s[28:31], s49 offen offset:1024 sc1 lds
    s_add_u32 s56, s51, s58
    s_add_u32 m0, s56, 16384
    s_nop 0
    buffer_load_dwordx4 v12, s[32:35], s50 offen lds
    s_add_u32 m0, s56, 17408
    s_nop 0
    buffer_load_dwordx4 v13, s[32:35], s50 offen lds
    s_add_u32 m0, s56, 24576
    s_nop 0
    buffer_load_dwordx4 v14, s[32:35], s50 offen lds
    s_add_u32 m0, s56, 25600
    s_nop 0
    buffer_load_dwordx4 v15, s[32:35], s50 offen lds
    s_mov_b32 s48, 5
    s_mov_b32 s51, 65536
    s_lshl_b32 s53, s48, 1
    s_lshr_b64 s[54:55], s[100:101], s53
    s_and_b32 s53, s54, 3
    s_add_u32 s53, s53, s48
    s_add_u32 s53, s53, s65
    s_mul_i32 s54, s53, 294
    s_add_u32 s55, s54, 147
    s_lshr_b32 s54, s54, 10
    s_lshr_b32 s55, s55, 10
    s_lshl_b32 s54, 1, s54
    s_lshl_b32 s55, 1, s55
    s_or_b32 s68, s54, s55
    s_mul_i32 s49, s53, 2048
    s_mul_i32 s50, s53, 131072
    s_add_u32 s47, s51, s57
    s_add_u32 m0, s47, 0
ploop_110:
    s_waitcnt vmcnt(8)
    s_barrier
    s_andn2_b32 s55, s68, s77
    s_cbranch_scc0 rdy_112
    s_mov_b32 exec_lo, 0xff
    s_mov_b32 exec_hi, 0
    s_mov_b32 s56, 0
nd_111:
    buffer_load_dword v31, v30, s[96:99], s63 offen sc1
    s_add_u32 s56, s56, 1
    s_waitcnt vmcnt(0)
    v_cmp_eq_u32 vcc, s62, v31
    s_nop 1
    s_cmp_gt_u32 s56, 0x20000
    s_cselect_b32 s77, -1, vcc_lo
    s_andn2_b32 s55, s68, s77
    s_cbranch_scc1 nd_111
    s_mov_b64 exec, -1
rdy_112:
    buffer_load_dwordx4 v10, s[28:31], s49 offen sc1 lds
    buffer_load_dwordx4 v10, s[28:31], s49 offen offset:1024 sc1 lds
    s_cmp_lg_u32 s48, 23
    s_cbranch_scc1 ct_113
    s_getpc_b64 s[78:79]
pc_114:
    s_sub_u32 s78, s78, pc_114-KSTART-60
    s_subb_u32 s79, s79, 0
    s_lshr_b32 s53, s2, 3
    s_lshl_b32 s53, s53, 2
    s_add_u32 s53, s53, s27
    s_lshl_b32 s53, s53, 7
    s_add_u32 s54, s53, 0
    s_min_u32 s54, s54, KEND-KSTART-68
    s_load_dwordx2 s[66:67], s[78:79], s54
    s_add_u32 s54, s53, 16384
    s_min_u32 s54, s54, KEND-KSTART-68
    s_load_dwordx2 s[66:67], s[78:79], s54
    s_add_u32 s54, s53, 32768
    s_min_u32 s54, s54, KEND-KSTART-68
    s_load_dwordx2 s[66:67], s[78:79], s54
ct_113:
    s_bitcmp1_b32 0xfffe0, s48
    s_cbranch_scc0 lp_115
    s_getreg_b32 s53, hwreg(HW_REG_IB_STS, 8, 4)
    s_cmp_gt_u32 s53, 8
    s_cbranch_scc1 lp_115
    s_cmp_ge_u32 s74, 7340032
    s_cbranch_scc1 lp_115
    s_add_u32 s78, s16, s74
    s_addc_u32 s79, s17, 0
    s_load_dwordx2 s[66:67], s[78:79], 60
    s_load_dwordx2 s[66:67], s[78:79], 188
    s_load_dwordx2 s[66:67], s[78:79], 316
    s_load_dword s66, s[78:79], 384
    s_add_u32 s74, s74, s75
    s_sub_u32 s75, 458752, s75
lp_115:
    s_add_u32 m0, s47, 2048
    s_add_u32 s52, s48, 1
    buffer_load_dwordx4 v11, s[28:31], s49 offen sc1 lds
    s_lshl_b32 s53, s52, 1
    s_lshr_b64 s[54:55], s[100:101], s53
    buffer_load_dwordx4 v11, s[28:31], s49 offen offset:1024 sc1 lds
    s_and_b32 s53, s54, 3
    s_add_u32 s53, s53, s52
    s_add_u32 s47, s51, s58
    s_add_u32 m0, s47, 16384
    s_add_u32 s53, s53, s65
    buffer_load_dwordx4 v12, s[32:35], s50 offen lds
    s_mul_i32 s54, s53, 294
    s_add_u32 s55, s54, 147
    s_add_u32 m0, s47, 17408
    s_lshr_b32 s54, s54, 10
    buffer_load_dwordx4 v13, s[32:35], s50 offen lds
    s_lshr_b32 s55, s55, 10
    s_lshl_b32 s54, 1, s54
    s_add_u32 m0, s47, 24576
    s_lshl_b32 s55, 1, s55
    buffer_load_dwordx4 v14, s[32:35], s50 offen lds
    s_or_b32 s68, s54, s55
    s_mul_i32 s3, s53, 2048
    s_add_u32 m0, s47, 25600
    s_mul_i32 s64, s53, 131072
    buffer_load_dwordx4 v15, s[32:35], s50 offen lds
    s_add_u32 s51, s51, 32768
    s_cmp_ge_u32 s51, 98304
    s_cselect_b32 s51, 0, s51
    s_mov_b32 s49, s3
    s_mov_b32 s50, s64
    s_mov_b32 s48, s52
    s_add_u32 s47, s51, s57
    s_add_u32 m0, s47, 0
    s_cmp_lt_u32 s48, 28
    s_cbranch_scc1 ploop_110
    s_waitcnt vmcnt(8)
    s_barrier
    s_waitcnt vmcnt(0)
    s_barrier
    s_barrier
    s_cmp_lg_u32 s2, 0
    s_cbranch_scc1 L_pend
    s_cmp_lg_u32 s26, 4
    s_cbranch_scc1 L_pend
    v_mov_b32 v28, 0
    v_mov_b32 v29, s62
    s_mov_b64 exec, 1
    buffer_store_dword v29, v28, s[96:99], 0 offen sc1
    s_mov_b64 exec, -1
L_pend:
L_done:
    s_endpgm
KEND:
.section .rodata,"a"
.p2align 6
.amdhsa_kernel sequential_preLN__sliding_local_dilated__dense_activation_gelu__prompt_kernel
  .amdhsa_next_free_vgpr 256
  .amdhsa_next_free_sgpr 102
  .amdhsa_accum_offset 256
  .amdhsa_group_segment_fixed_size 0
  .amdhsa_kernarg_size 88
  .amdhsa_user_sgpr_count 2
  .amdhsa_user_sgpr_kernarg_segment_ptr 1
  .amdhsa_system_sgpr_workgroup_id_x 1
  .amdhsa_float_denorm_mode_32 3
.end_amdhsa_kernel
```
